```python
import torch

def _softmax(x, axis=-1):
    return torch.softmax(x, dim=axis)

def _gelu(x):
    return torch.nn.functional.gelu(x, approximate='tanh')

def _silu(x):
    return torch.nn.functional.silu(x)

def _sigmoid(x):
    return torch.sigmoid(x)

def _layernorm(x, axis=-1, eps=1e-05):
    m = x.mean(dim=axis, keepdim=True)
    v = x.var(dim=axis, keepdim=True, unbiased=False)
    return (x - m) / torch.sqrt(v + eps)

def _scatter_add(tgt, idx, src, axis=0):
    return tgt.clone().index_add_(axis, idx, src)

def _segment_sum(src, seg, n):
    out = torch.zeros((n,) + src.shape[1:], dtype=src.dtype)
    return out.index_add_(0, seg, src)

def _pad(x, pw):
    flat = tuple((v for pair in reversed(pw) for v in pair))
    return torch.nn.functional.pad(x, flat)
kernel_name = 'adaLN_cond__ssm_conv_h3__glu_gated_reglu__prompt'

def setup_inputs():

    _w = lambda a: (lambda t: t.to(torch.bfloat16) if t.is_floating_point() else t)(torch.as_tensor(a))

    def _A_setup():
        B, S, D = (1, 2048, 448)
        ks = 4
        return {'q': _w((lambda *s: torch.randn(*s, dtype=torch.bfloat16) * 0.05)(B, S, D)), 'k': _w((lambda *s: torch.randn(*s, dtype=torch.bfloat16) * 0.8)(B, S, D)), 'v': _w((lambda *s: torch.randn(*s, dtype=torch.bfloat16) * 0.8)(B, S, D)), 'shift_k': _w((lambda *s: torch.randn(*s, dtype=torch.bfloat16) * 0.8)(D, ks) * 0.5), 'ssm_k': _w((lambda *s: torch.randn(*s, dtype=torch.bfloat16) * 0.8)(D, S) * (1.0 / S ** 0.5)), 'ssm_D': _w((lambda *s: torch.randn(*s, dtype=torch.bfloat16) * 0.8)(D))}
    _A_in = _A_setup()

    def _B_setup():
        B, S, D, F = (1, 2048, 448, 1792)
        return {'x': _w((lambda *s: torch.randn(*s, dtype=torch.bfloat16) * 0.05)(B, S, D)), 'W_gate': _w((lambda *s: torch.randn(*s, dtype=torch.bfloat16) * 0.8)(D, F) * (2.0 / D) ** 0.5), 'W_up': _w((lambda *s: torch.randn(*s, dtype=torch.bfloat16) * 0.8)(D, F) * (2.0 / D) ** 0.5), 'W_down': _w((lambda *s: torch.randn(*s, dtype=torch.bfloat16) * 0.8)(F, D) * (1.0 / F) ** 0.5)}
    _B_in = _B_setup()
    return {'A_q': _A_in['q'], 'A_k': _A_in['k'], 'A_v': _A_in['v'], 'A_shift_k': _A_in['shift_k'], 'A_ssm_k': _A_in['ssm_k'], 'A_ssm_D': _A_in['ssm_D'], 'B_x': _B_in['x'], 'B_W_gate': _B_in['W_gate'], 'B_W_up': _B_in['W_up'], 'B_W_down': _B_in['W_down'], 'c': _w((lambda *s: torch.randn(*s, dtype=torch.bfloat16) * 0.2)(1, 448) * 8.0), 'w_mod': _w((lambda *s: torch.randn(*s, dtype=torch.bfloat16) * 0.2)(448, 6 * 448) * 448 ** (-0.5) * 8.0)}

def reference(A_q, A_k, A_v, A_shift_k, A_ssm_k, A_ssm_D, B_x, B_W_gate, B_W_up, B_W_down, c, w_mod):

    def _A_ref(q, k, v, shift_k, ssm_k, ssm_D):
        B, S, D = q.shape
        ks = shift_k.shape[-1]
        k_pad = _pad(k, ((0, 0), (ks - 1, 0), (0, 0)))
        k_shift = torch.zeros_like(k)
        for t in range(ks):
            k_shift = k_shift + k_pad[:, t:t + S, :] * shift_k[:, ks - 1 - t][None, None, :]
        kv = k_shift * v
        L = 2 * S
        kv_pad = _pad(kv, ((0, 0), (0, S), (0, 0)))
        kf_pad = _pad(ssm_k, ((0, 0), (0, S)))
        kv_f = (lambda x, axes=(-2, -1): torch.fft.rfft2(x.float(), dim=axes))(kv_pad[:, None, :, :], axes=(1, 2))
        kf_f = (lambda x, axes=(-2, -1): torch.fft.rfft2(x.float(), dim=axes))(kf_pad[:, None, :], axes=(1, 2))
        kf_f = (lambda x, *d: x.permute(*d))(kf_f, 1, 2, 0)
        y_f = kv_f * kf_f[None, :, :, :]
        y = (lambda x, s, axes=(-2, -1): torch.fft.irfft2(x, s=s, dim=axes).to(torch.bfloat16))(y_f, (1, L), axes=(1, 2))[:, 0, :S, :]
        y = y + kv * ssm_D[None, None, :]
        return q * y

    def _B_ref(x, W_gate, W_up, W_down):
        gate = torch.einsum('bsd,df->bsf', x, W_gate)
        up = torch.einsum('bsd,df->bsf', x, W_up)
        gate = gate * (lambda x, dt: x.to(dt))(gate > 0, gate.dtype)
        h = gate * up
        return torch.einsum('bsf,fd->bsd', h, W_down)
    x = A_q
    mod = (_silu(c) @ w_mod).reshape(c.shape[0], 6, 1, -1)
    sa, ca, ga, sb, cb, gb = (mod[:, 0].clone(), mod[:, 1].clone(), mod[:, 2].clone(), mod[:, 3].clone(), mod[:, 4].clone(), mod[:, 5].clone())
    h = _layernorm(x, axis=-1) * (1 + ca) + sa
    x = x + ga * _A_ref(h, A_k, A_v, A_shift_k, A_ssm_k, A_ssm_D)
    h = _layernorm(x, axis=-1) * (1 + cb) + sb
    x = x + gb * _B_ref(h, B_W_gate, B_W_up, B_W_down)
    return x
```

```asm
; @launch grid=(256,1,1) block=(256,1,1) lds=163840
.amdgcn_target "amdgcn-amd-amdhsa--gfx950"
.text
.globl adaLN_cond__ssm_conv_h3__glu_gated_reglu__prompt_kernel
.p2align 8
.type adaLN_cond__ssm_conv_h3__glu_gated_reglu__prompt_kernel,@function
adaLN_cond__ssm_conv_h3__glu_gated_reglu__prompt_kernel:
    s_cmp_ge_u32 s2, 256
    s_cbranch_scc1 k_end
    s_load_dwordx16 s[36:51], s[0:1], 0
    s_load_dwordx8 s[52:59], s[0:1], 64
    s_load_dwordx2 s[60:61], s[0:1], 96
    s_load_dwordx2 s[8:9], s[0:1], 112
    s_cmp_ge_u32 s2, 32
    s_cbranch_scc1 k_main
    s_getpc_b64 s[14:15]
k_pfpc:
    s_sub_u32 s14, s14, k_pfpc-adaLN_cond__ssm_conv_h3__glu_gated_reglu__prompt_kernel
    s_subb_u32 s15, s15, 0
    s_lshr_b32 s3, s2, 3
    s_lshl_b32 s3, s3, 12
    s_add_u32 s12, s3, 16384
    s_min_u32 s12, s12, code_end-adaLN_cond__ssm_conv_h3__glu_gated_reglu__prompt_kernel-4096
    v_mov_b32 v201, 0
    v_mov_b32 v203, 0
    v_lshl_add_u32 v200, v0, 4, s3
    v_lshl_add_u32 v202, v0, 4, s12
    v_lshl_add_u64 v[200:201], v[200:201], 0, s[14:15]
    v_lshl_add_u64 v[202:203], v[202:203], 0, s[14:15]
    global_load_dwordx4 v[204:207], v[200:201], off
    global_load_dwordx4 v[204:207], v[202:203], off
    s_branch k_spare
k_main:
    s_mov_b32 s10, 0x2100000
    s_mov_b32 s11, 0x20000
    v_lshrrev_b32 v1, 6, v0
    v_and_b32 v2, 63, v0
    v_readfirstlane_b32 s23, v1
    v_lshlrev_b32 v3, 4, v2
    s_and_b32 s24, s2, 7
    s_lshr_b32 s25, s2, 3
    s_and_b32 s21, s25, 3
    s_lshl2_add_u32 s4, s24, s21
    s_mov_b32 s70, 0x1c0000
    s_mov_b32 s71, 0x20000
    s_sub_u32 s25, s25, 4
    s_lshr_b32 s29, s25, 2
    s_mul_i32 s20, s4, 57344
    s_lshl_b32 s21, s29, 7
    s_add_u32 s20, s20, s21
    v_and_b32 v35, 31, v0
    v_lshrrev_b32 v36, 5, v0
    v_mul_u32_u24 v32, 7168, v36
    v_lshl_add_u32 v32, v35, 2, v32
    v_add_u32 v32, s20, v32
    v_add_u32 v33, 0xfffff580, v32
    s_lshl_b32 s21, s29, 9
    v_lshl_add_u32 v34, v35, 4, s21
    s_movk_i32 s22, 4480
    s_mul_i32 s26, s24, 28
    s_add_u32 s26, s26, s25
    s_lshl_b32 s30, s26, 13
    s_add_u32 s31, s30, 4096
    v_lshlrev_b32 v4, 4, v0
    v_add_u32 v5, -4, v4
    s_movk_i32 s74, 3584
    s_mov_b32 s75, 0x20000
    s_lshl_b32 s3, s26, 2
    s_waitcnt lgkmcnt(0)
    s_load_dword s20, s[46:47], s3
    s_mov_b32 s68, s38
    s_mov_b32 s69, s39
    s_mov_b32 s72, s42
    s_mov_b32 s73, s43
    buffer_load_dword v44, v33, s[68:71], 0 offen offset:0
    buffer_load_dword v45, v33, s[68:71], 0 offen offset:896
    buffer_load_dword v46, v33, s[68:71], 0 offen offset:1792
    buffer_load_dword v47, v32, s[68:71], 0 offen offset:0
    buffer_load_dword v48, v32, s[68:71], 0 offen offset:896
    buffer_load_dword v49, v32, s[68:71], 0 offen offset:1792
    buffer_load_dword v50, v32, s[68:71], 0 offen offset:2688
    buffer_load_dword v51, v32, s[68:71], 0 offen offset:3584
    buffer_load_dword v52, v32, s[68:71], s22 offen offset:0
    buffer_load_dword v53, v32, s[68:71], s22 offen offset:896
    buffer_load_dword v54, v32, s[68:71], s22 offen offset:1792
    buffer_load_dwordx4 v[40:43], v34, s[72:75], 0 offen
    s_mov_b32 s68, s40
    s_mov_b32 s69, s41
    buffer_load_dword v55, v32, s[68:71], 0 offen offset:0
    buffer_load_dword v56, v32, s[68:71], 0 offen offset:896
    buffer_load_dword v57, v32, s[68:71], 0 offen offset:1792
    buffer_load_dword v58, v32, s[68:71], 0 offen offset:2688
    buffer_load_dword v59, v32, s[68:71], 0 offen offset:3584
    buffer_load_dword v60, v32, s[68:71], s22 offen offset:0
    buffer_load_dword v61, v32, s[68:71], s22 offen offset:896
    buffer_load_dword v62, v32, s[68:71], s22 offen offset:1792
    s_mov_b32 s68, s36
    s_mov_b32 s69, s37
    buffer_load_dword v64, v32, s[68:71], 0 offen offset:0
    buffer_load_dword v65, v32, s[68:71], 0 offen offset:896
    buffer_load_dword v66, v32, s[68:71], 0 offen offset:1792
    buffer_load_dword v67, v32, s[68:71], 0 offen offset:2688
    buffer_load_dword v68, v32, s[68:71], 0 offen offset:3584
    buffer_load_dword v69, v32, s[68:71], s22 offen offset:0
    buffer_load_dword v70, v32, s[68:71], s22 offen offset:896
    buffer_load_dword v71, v32, s[68:71], s22 offen offset:1792
    s_mov_b32 s68, s44
    s_mov_b32 s69, s45
    buffer_load_dwordx4 v[208:211], v4, s[68:71], s30 offen
    buffer_load_dwordx4 v[212:215], v4, s[68:71], s31 offen
    buffer_load_dword v216, v5, s[68:71], s30 offen
    buffer_load_dword v217, v5, s[68:71], s31 offen
    s_branch k_splice
k_spare:
    s_mov_b32 s10, 0x2100000
    s_mov_b32 s11, 0x20000
    v_lshrrev_b32 v1, 6, v0
    v_and_b32 v2, 63, v0
    v_readfirstlane_b32 s23, v1
    v_lshlrev_b32 v3, 4, v2
    s_and_b32 s24, s2, 7
    s_lshr_b32 s25, s2, 3
    s_and_b32 s21, s25, 3
    s_lshl2_add_u32 s4, s24, s21
    s_mov_b32 s70, 0x1c0000
    s_mov_b32 s71, 0x20000
    v_lshlrev_b32 v129, 26, v2
    s_lshl2_add_u32 s30, s4, s23
    s_lshl_b32 s3, s30, 4
    v_lshrrev_b32 v8, 3, v2
    v_add_u32 v9, s3, v8
    v_and_b32 v10, 7, v2
    v_mul_u32_u24 v11, 896, v9
    v_lshl_add_u32 v11, v10, 4, v11
    s_movk_i32 s31, 7168
    s_waitcnt lgkmcnt(0)
    v_mov_b32 v78, 6352896
    buffer_load_dword v78, v78, s[8:11], 0 offen sc1
    s_mov_b32 s68, s36
    s_mov_b32 s69, s37
    buffer_load_dwordx4 v[16:19], v11, s[68:71], 0 offen offset:0
    buffer_load_dwordx4 v[20:23], v11, s[68:71], 0 offen offset:128
    buffer_load_dwordx4 v[24:27], v11, s[68:71], 0 offen offset:256
    buffer_load_dwordx4 v[28:31], v11, s[68:71], 0 offen offset:384
    buffer_load_dwordx4 v[32:35], v11, s[68:71], 0 offen offset:512
    buffer_load_dwordx4 v[36:39], v11, s[68:71], 0 offen offset:640
    buffer_load_dwordx4 v[40:43], v11, s[68:71], 0 offen offset:768
    buffer_load_dwordx4 v[44:47], v11, s[68:71], s31 offen offset:0
    buffer_load_dwordx4 v[48:51], v11, s[68:71], s31 offen offset:128
    buffer_load_dwordx4 v[52:55], v11, s[68:71], s31 offen offset:256
    buffer_load_dwordx4 v[56:59], v11, s[68:71], s31 offen offset:384
    buffer_load_dwordx4 v[60:63], v11, s[68:71], s31 offen offset:512
    buffer_load_dwordx4 v[64:67], v11, s[68:71], s31 offen offset:640
    buffer_load_dwordx4 v[68:71], v11, s[68:71], s31 offen offset:768
    s_branch k_spare2
k_splice:
    s_sub_u32 s3, s2, 32
    s_mul_i32 s64, s3, 1561
    s_lshr_b32 s64, s64, 16
    s_mul_i32 s65, s64, 42
    s_sub_u32 s65, s3, s65
    s_mul_i32 s21, s64, 96
    v_lshrrev_b32 v184, 3, v0
    v_add_u32 v184, s21, v184
    v_and_b32 v185, 7, v0
    v_mul_u32_u24 v186, 5376, v184
    v_lshl_add_u32 v186, v185, 4, v186
    s_lshl_b32 s21, s65, 7
    v_add_u32 v186, s21, v186
    v_add_u32 v187, 172032, v186
    v_add_u32 v188, 344064, v186
    v_lshlrev_b32 v184, 1, v184
    s_cmp_ge_u32 s23, 2
    s_cselect_b32 s12, s52, s50
    s_cselect_b32 s13, s53, s51
    s_mov_b32 s14, 1605632
    s_mov_b32 s15, 0x20000
    s_mov_b32 s16, s60
    s_mov_b32 s17, s61
    s_mov_b32 s18, 0x1c0000
    s_mov_b32 s19, 0x20000
    v_and_b32 v37, 7, v35
    v_xor_b32 v37, v36, v37
    v_lshlrev_b32 v37, 4, v37
    v_lshl_add_u32 v37, v35, 8, v37
    v_bfe_u32 v38, v0, 4, 3
    v_xor_b32 v38, v0, v38
    v_lshlrev_b32 v38, 4, v38
    v_lshrrev_b32 v39, 3, v0
    v_lshlrev_b32 v39, 12, v39
    v_lshl_add_u32 v39, v185, 4, v39
    s_lshl_b32 s3, s29, 18
    s_lshl_b32 s76, s4, 7
    s_add_u32 s76, s76, s3
    s_add_u32 s77, s76, 0x20000
    s_add_u32 s78, s76, 2097152
    s_add_u32 s79, s77, 2097152
    s_mov_b32 s80, 0x05040100
    s_mov_b32 s81, 0x07060302
    s_lshl2_add_u32 s3, s29, s23
    s_lshl_b32 s3, s3, 5
    s_add_u32 s3, s3, s4
    s_lshl_b32 s3, s3, 7
    s_add_u32 s66, s3, 6553600
    s_mul_i32 s67, s64, 21504
    s_lshl_b32 s3, s65, 9
    s_add_u32 s67, s67, s3
    s_add_u32 s67, s67, 6946816
    s_cmp_ge_u32 s64, 5
    s_cselect_b32 s64, 0x40000000, 0
    s_lshl_b32 s36, s23, 11
    s_add_u32 s32, s36, s30
    s_lshr_b32 s33, s23, 1
    s_and_b32 s34, s23, 1
    v_lshrrev_b32 v10, 4, v2
    v_and_b32 v7, 15, v2
    s_lshl_b32 s3, s33, 2
    v_or_b32 v6, s3, v10
    v_lshlrev_b32 v6, 1, v6
    v_xor_b32 v6, v6, v7
    v_mul_u32_u24 v252, 3584, v10
    v_lshl_add_u32 v252, v6, 4, v252
    v_add_u32 v255, 13312, v252
    s_lshr_b32 s27, s24, 2
    s_lshl_b32 s27, s27, 3
    s_bfe_u32 s28, s24, 0x10001
    s_and_b32 s3, s24, 1
    s_mul_i32 s3, s3, 28
    s_add_u32 s3, s3, s25
    s_lshr_b32 s6, s3, 3
    s_and_b32 s3, s3, 7
    s_add_u32 s27, s27, s3
    s_mul_i32 s3, s28, 7
    s_add_u32 s3, s3, s6
    s_lshl_b32 s3, s3, 8
    s_mul_i32 s42, s34, 28672
    s_add_u32 s42, s42, s3
    s_add_u32 s82, s36, 65536
    v_bfe_u32 v6, v2, 2, 3
    s_lshl_b32 s3, s23, 1
    v_xor_b32 v6, s3, v6
    v_lshlrev_b32 v6, 5, v6
    v_and_b32 v8, 3, v2
    v_lshl_add_u32 v6, v8, 3, v6
    v_bfe_u32 v8, v2, 2, 2
    v_lshl_add_u32 v6, v8, 8, v6
    v_lshrrev_b32 v8, 5, v2
    v_lshl_add_u32 v6, v8, 11, v6
    v_bfe_u32 v8, v2, 4, 1
    v_lshl_add_u32 v6, v8, 12, v6
    v_add_u32 v253, 65536, v6
    v_xor_b32 v254, 32, v253
    v_and_b32 v1, 32, v2
    v_lshlrev_b32 v1, 25, v1
    v_lshl_add_u32 v1, v2, 2, v1
    s_mul_i32 s35, s33, 4608
    s_lshl_b32 s3, s34, 11
    s_add_u32 s3, s3, s35
    s_add_u32 s65, s3, 512
    v_and_b32 v6, 7, v2
    v_lshrrev_b32 v7, 3, v2
    v_add_u32 v9, 3, v6
    v_mul_u32_u24 v6, 21504, v6
    v_mul_u32_u24 v8, 3584, v7
    v_and_b32 v9, 8, v9
    v_lshlrev_b32 v9, 26, v9
    v_add3_u32 v5, v6, v8, v9
    v_mov_b32 v9, 0xe8
    v_lshrrev_b32 v9, v7, v9
    v_lshl_or_b32 v5, v9, 31, v5
    s_lshl_b32 s3, s26, 4
    s_add_u32 s31, s3, 6946816
    v_bfe_u32 v25, v2, 2, 1
    v_and_b32 v10, 3, v2
    v_lshl_add_u32 v10, v7, 2, v10
    v_lshlrev_b32 v249, 5, v10
    v_lshlrev_b32 v10, 4, v10
    v_lshl_add_u32 v248, v25, 12, v10
    s_add_u32 s37, s36, 6291456
    s_add_u32 s38, s36, 6299648
    s_lshl_b32 s22, s23, 9
    s_add_u32 s39, s22, s30
    s_add_u32 s39, s39, 2097152
    v_mul_u32_u24 v23, 4608, v25
    s_add_u32 s22, s22, 512
    v_add3_u32 v23, v23, v10, s22
    v_mul_u32_u24 v24, 28672, v7
    v_and_b32 v6, 0x70, v3
    v_add_u32 v24, v24, v6
    v_and_b32 v6, 3, v7
    v_xor_b32 v6, v6, v25
    v_lshlrev_b32 v6, 4, v6
    v_xor_b32 v6, v6, v249
    v_lshl_add_u32 v6, v25, 14, v6
    s_lshl_b32 s22, s23, 10
    s_add_u32 s22, s22, 25856
    v_xor_b32 v26, 16, v6
    v_add_u32 v22, s22, v6
    v_add_u32 v26, s22, v26
    v_lshrrev_b32 v6, 1, v249
    v_and_b32 v6, 0x70, v6
    v_and_b32 v249, 0x300, v249
    v_lshl_add_u32 v249, v249, 1, v6
    v_and_b32 v7, 15, v2
    v_lshrrev_b32 v10, 4, v2
    v_and_b32 v11, 1, v2
    v_xor_b32 v11, 1, v11
    v_mul_u32_u24 v11, 4160, v11
    v_lshrrev_b32 v16, 1, v7
    v_lshl_add_u32 v16, v10, 2, v16
    v_lshl_add_u32 v16, v16, 2, v11
    s_mul_i32 s22, s33, 8320
    s_lshl_b32 s3, s34, 8
    s_add_u32 s22, s22, s3
    s_add_u32 s22, s22, 9220
    v_add_u32 v16, s22, v16
    v_add_u32 v17, 1024, v16
    v_add_u32 v18, 2048, v16
    v_add_u32 v19, 3072, v16
    v_lshlrev_b32 v20, 1, v7
    v_sub_u32 v20, v20, v10
    s_sub_u32 s22, s35, s3
    s_add_u32 s22, s22, 336
    v_lshl_add_u32 v20, v20, 4, s22
    v_bfe_u32 v21, v2, 1, 2
    v_xor_b32 v21, v21, v10
    v_xor_b32 v21, s33, v21
    v_lshl_add_u32 v21, v7, 2, v21
    s_lshl_b32 s22, s23, 13
    s_add_u32 s22, s22, 25856
    v_lshl_add_u32 v21, v21, 4, s22
    v_xor_b32 v25, 1, v25
    v_lshlrev_b32 v25, 4, v25
    s_mul_i32 s40, s23, 229376
    s_lshl_b32 s3, s26, 7
    s_add_u32 s3, s40, s3
    s_add_u32 s40, s3, 25165824
    s_add_u32 s41, s3, 4194304
    s_waitcnt vmcnt(20)
    v_mov_b32 v171, 6352896
    buffer_load_dword v171, v171, s[8:11], 0 offen sc1
    s_mov_b32 s72, s56
    s_mov_b32 s73, s57
    s_movk_i32 s74, 896
    buffer_load_ushort v168, v184, s[72:75], 0 offen offset:0
    buffer_load_ushort v169, v184, s[72:75], 0 offen offset:64
    buffer_load_ushort v170, v184, s[72:75], 0 offen offset:128
    s_mov_b32 s72, s58
    s_mov_b32 s73, s59
    s_mov_b32 s74, 2408448
    buffer_load_dwordx4 v[172:175], v186, s[72:75], 0 offen
    buffer_load_dwordx4 v[176:179], v187, s[72:75], 0 offen
    buffer_load_dwordx4 v[180:183], v188, s[72:75], 0 offen
    v_lshlrev_b32 v72, 16, v44
    v_and_b32 v73, 0xffff0000, v44
    v_lshlrev_b32 v74, 16, v45
    v_and_b32 v75, 0xffff0000, v45
    v_lshlrev_b32 v76, 16, v46
    v_and_b32 v77, 0xffff0000, v46
    v_lshlrev_b32 v78, 16, v47
    v_and_b32 v79, 0xffff0000, v47
    v_lshlrev_b32 v80, 16, v48
    v_and_b32 v81, 0xffff0000, v48
    v_lshlrev_b32 v82, 16, v49
    v_and_b32 v83, 0xffff0000, v49
    v_lshlrev_b32 v84, 16, v50
    v_and_b32 v85, 0xffff0000, v50
    v_lshlrev_b32 v86, 16, v51
    v_and_b32 v87, 0xffff0000, v51
    v_lshlrev_b32 v88, 16, v52
    v_and_b32 v89, 0xffff0000, v52
    v_lshlrev_b32 v90, 16, v53
    v_and_b32 v91, 0xffff0000, v53
    v_lshlrev_b32 v92, 16, v54
    v_and_b32 v93, 0xffff0000, v54
    v_lshlrev_b32 v110, 16, v40
    v_and_b32 v112, 0xffff0000, v40
    v_lshlrev_b32 v114, 16, v41
    v_and_b32 v116, 0xffff0000, v41
    v_lshlrev_b32 v111, 16, v42
    v_and_b32 v113, 0xffff0000, v42
    v_lshlrev_b32 v115, 16, v43
    v_and_b32 v117, 0xffff0000, v43
    v_pk_mul_f32 v[118:119], v[78:79], v[110:111]
    v_pk_mul_f32 v[120:121], v[80:81], v[110:111]
    v_pk_mul_f32 v[122:123], v[82:83], v[110:111]
    v_pk_mul_f32 v[124:125], v[84:85], v[110:111]
    v_pk_mul_f32 v[126:127], v[86:87], v[110:111]
    v_pk_mul_f32 v[128:129], v[88:89], v[110:111]
    v_pk_mul_f32 v[130:131], v[90:91], v[110:111]
    v_pk_mul_f32 v[132:133], v[92:93], v[110:111]
    v_pk_fma_f32 v[118:119], v[76:77], v[112:113], v[118:119]
    v_pk_fma_f32 v[120:121], v[78:79], v[112:113], v[120:121]
    v_pk_fma_f32 v[122:123], v[80:81], v[112:113], v[122:123]
    v_pk_fma_f32 v[124:125], v[82:83], v[112:113], v[124:125]
    v_pk_fma_f32 v[126:127], v[84:85], v[112:113], v[126:127]
    v_pk_fma_f32 v[128:129], v[86:87], v[112:113], v[128:129]
    v_pk_fma_f32 v[130:131], v[88:89], v[112:113], v[130:131]
    v_pk_fma_f32 v[132:133], v[90:91], v[112:113], v[132:133]
    v_pk_fma_f32 v[118:119], v[74:75], v[114:115], v[118:119]
    v_pk_fma_f32 v[120:121], v[76:77], v[114:115], v[120:121]
    v_pk_fma_f32 v[122:123], v[78:79], v[114:115], v[122:123]
    v_pk_fma_f32 v[124:125], v[80:81], v[114:115], v[124:125]
    v_pk_fma_f32 v[126:127], v[82:83], v[114:115], v[126:127]
    v_pk_fma_f32 v[128:129], v[84:85], v[114:115], v[128:129]
    v_pk_fma_f32 v[130:131], v[86:87], v[114:115], v[130:131]
    v_pk_fma_f32 v[132:133], v[88:89], v[114:115], v[132:133]
    v_pk_fma_f32 v[118:119], v[72:73], v[116:117], v[118:119]
    v_pk_fma_f32 v[120:121], v[74:75], v[116:117], v[120:121]
    v_pk_fma_f32 v[122:123], v[76:77], v[116:117], v[122:123]
    v_pk_fma_f32 v[124:125], v[78:79], v[116:117], v[124:125]
    v_pk_fma_f32 v[126:127], v[80:81], v[116:117], v[126:127]
    v_pk_fma_f32 v[128:129], v[82:83], v[116:117], v[128:129]
    v_pk_fma_f32 v[130:131], v[84:85], v[116:117], v[130:131]
    v_pk_fma_f32 v[132:133], v[86:87], v[116:117], v[132:133]
    s_waitcnt vmcnt(19)
    v_lshlrev_b32 v94, 16, v55
    v_and_b32 v95, 0xffff0000, v55
    v_lshlrev_b32 v96, 16, v56
    v_and_b32 v97, 0xffff0000, v56
    v_lshlrev_b32 v98, 16, v57
    v_and_b32 v99, 0xffff0000, v57
    v_lshlrev_b32 v100, 16, v58
    v_and_b32 v101, 0xffff0000, v58
    v_lshlrev_b32 v102, 16, v59
    v_and_b32 v103, 0xffff0000, v59
    v_lshlrev_b32 v104, 16, v60
    v_and_b32 v105, 0xffff0000, v60
    v_lshlrev_b32 v106, 16, v61
    v_and_b32 v107, 0xffff0000, v61
    v_lshlrev_b32 v108, 16, v62
    v_and_b32 v109, 0xffff0000, v62
    v_pk_mul_f32 v[118:119], v[118:119], v[94:95]
    v_pk_mul_f32 v[120:121], v[120:121], v[96:97]
    v_pk_mul_f32 v[122:123], v[122:123], v[98:99]
    v_pk_mul_f32 v[124:125], v[124:125], v[100:101]
    v_pk_mul_f32 v[126:127], v[126:127], v[102:103]
    v_pk_mul_f32 v[128:129], v[128:129], v[104:105]
    v_pk_mul_f32 v[130:131], v[130:131], v[106:107]
    v_pk_mul_f32 v[132:133], v[132:133], v[108:109]
    v_cvt_pk_bf16_f32 v136, v132, v130
    v_cvt_pk_bf16_f32 v137, v128, v126
    v_cvt_pk_bf16_f32 v138, v124, v122
    v_cvt_pk_bf16_f32 v139, v120, v118
    ds_write_b128 v37, v[136:139] offset:25856
    v_cvt_pk_bf16_f32 v140, v133, v131
    v_cvt_pk_bf16_f32 v141, v129, v127
    v_cvt_pk_bf16_f32 v142, v125, v123
    v_cvt_pk_bf16_f32 v143, v121, v119
    ds_write_b128 v37, v[140:143] offset:25984
    s_waitcnt vmcnt(11)
    v_perm_b32 v160, v65, v64, s80
    v_perm_b32 v161, v67, v66, s80
    v_perm_b32 v162, v69, v68, s80
    v_perm_b32 v163, v71, v70, s80
    ds_write_b128 v37, v[160:163] offset:34048
    v_perm_b32 v164, v65, v64, s81
    v_perm_b32 v165, v67, v66, s81
    v_perm_b32 v166, v69, v68, s81
    v_perm_b32 v167, v71, v70, s81
    ds_write_b128 v37, v[164:167] offset:34176
    s_waitcnt lgkmcnt(0)
    s_barrier
    ds_read_b128 v[144:147], v38 offset:25856
    ds_read_b128 v[148:151], v38 offset:29952
    ds_read_b128 v[152:155], v38 offset:34048
    ds_read_b128 v[156:159], v38 offset:38144
    s_waitcnt lgkmcnt(3)
    buffer_store_dwordx4 v[144:147], v39, s[8:11], s76 offen sc1
    s_waitcnt lgkmcnt(2)
    buffer_store_dwordx4 v[148:151], v39, s[8:11], s77 offen sc1
    s_waitcnt lgkmcnt(1)
    buffer_store_dwordx4 v[152:155], v39, s[8:11], s78 offen sc1
    s_waitcnt lgkmcnt(0)
    buffer_store_dwordx4 v[156:159], v39, s[8:11], s79 offen sc1
    s_add_u32 m0, s82, 0x0
    s_nop 0
    buffer_load_dwordx4 v252, s[12:15], s42 offen offset:0 lds
    buffer_load_dwordx4 v255, s[12:15], s42 offen offset:1024 lds
    s_add_u32 m0, s82, 0x2000
    s_add_u32 s42, s42, 57344
    buffer_load_dwordx4 v252, s[12:15], s42 offen offset:0 lds
    buffer_load_dwordx4 v255, s[12:15], s42 offen offset:1024 lds
    v_mov_b32 v12, 0
    v_mov_b32 v13, 0
    v_mov_b32 v14, 0
    v_mov_b32 v15, 0
    v_lshrrev_b32 v10, 5, v0
    v_mul_u32_u24 v10, 4096, v10
    v_add_u32 v10, v10, v4
    v_bfe_u32 v11, v0, 1, 2
    v_mul_u32_u24 v11, 4160, v11
    v_and_b32 v9, 16, v4
    v_add_u32 v11, 9216, v11
    v_cmp_gt_u32 vcc, 64, v0
    v_add_u32 v11, v11, v9
    v_add_u32 v4, 9248, v4
    v_cndmask_b32 v10, v11, v10, vcc
    ds_write_b128 v10, v[12:15]
    s_waitcnt vmcnt(15)
    ds_write_b128 v4, v[208:211] offset:0
    v_alignbit_b32 v220, v208, v216, 16
    v_alignbit_b32 v221, v209, v208, 16
    v_alignbit_b32 v222, v210, v209, 16
    v_alignbit_b32 v223, v211, v210, 16
    ds_write_b128 v4, v[220:223] offset:4160
    ds_write_b128 v4, v[212:215] offset:8320
    v_alignbit_b32 v224, v212, v217, 16
    v_alignbit_b32 v225, v213, v212, 16
    v_alignbit_b32 v226, v214, v213, 16
    v_alignbit_b32 v227, v215, v214, 16
    ds_write_b128 v4, v[224:227] offset:12480
    s_mov_b32 s21, 0xbfb8aa3b
    s_waitcnt vmcnt(11)
    v_lshlrev_b32 v168, 16, v168
    v_lshlrev_b32 v169, 16, v169
    v_lshlrev_b32 v170, 16, v170
    v_mul_f32 v186, s21, v168
    v_mul_f32 v187, s21, v169
    v_mul_f32 v188, s21, v170
    v_exp_f32 v186, v186
    v_exp_f32 v187, v187
    v_exp_f32 v188, v188
    s_nop 0
    v_add_f32 v186, 1.0, v186
    v_add_f32 v187, 1.0, v187
    v_add_f32 v188, 1.0, v188
    v_rcp_f32 v186, v186
    v_rcp_f32 v187, v187
    v_rcp_f32 v188, v188
    s_nop 0
    v_mul_f32 v186, v186, v168
    v_mul_f32 v187, v187, v169
    v_mul_f32 v188, v188, v170
    v_cvt_pk_bf16_f32 v168, v186, v187
    v_cvt_pk_bf16_f32 v169, v188, v188
    v_lshlrev_b32 v186, 16, v168
    v_and_b32 v188, 0xffff0000, v168
    v_lshlrev_b32 v190, 16, v169
    s_waitcnt vmcnt(8)
    v_lshlrev_b32 v200, 16, v172
    v_and_b32 v201, 0xffff0000, v172
    v_lshlrev_b32 v202, 16, v173
    v_and_b32 v203, 0xffff0000, v173
    v_lshlrev_b32 v204, 16, v174
    v_and_b32 v205, 0xffff0000, v174
    v_lshlrev_b32 v206, 16, v175
    v_and_b32 v207, 0xffff0000, v175
    v_pk_mul_f32 v[192:193], v[200:201], v[186:187] op_sel_hi:[1,0]
    v_pk_mul_f32 v[194:195], v[202:203], v[186:187] op_sel_hi:[1,0]
    v_pk_mul_f32 v[196:197], v[204:205], v[186:187] op_sel_hi:[1,0]
    v_pk_mul_f32 v[198:199], v[206:207], v[186:187] op_sel_hi:[1,0]
    v_lshlrev_b32 v200, 16, v176
    v_and_b32 v201, 0xffff0000, v176
    v_lshlrev_b32 v202, 16, v177
    v_and_b32 v203, 0xffff0000, v177
    v_lshlrev_b32 v204, 16, v178
    v_and_b32 v205, 0xffff0000, v178
    v_lshlrev_b32 v206, 16, v179
    v_and_b32 v207, 0xffff0000, v179
    v_pk_fma_f32 v[192:193], v[200:201], v[188:189], v[192:193] op_sel_hi:[1,0,1]
    v_pk_fma_f32 v[194:195], v[202:203], v[188:189], v[194:195] op_sel_hi:[1,0,1]
    v_pk_fma_f32 v[196:197], v[204:205], v[188:189], v[196:197] op_sel_hi:[1,0,1]
    v_pk_fma_f32 v[198:199], v[206:207], v[188:189], v[198:199] op_sel_hi:[1,0,1]
    v_lshlrev_b32 v200, 16, v180
    v_and_b32 v201, 0xffff0000, v180
    v_lshlrev_b32 v202, 16, v181
    v_and_b32 v203, 0xffff0000, v181
    v_lshlrev_b32 v204, 16, v182
    v_and_b32 v205, 0xffff0000, v182
    v_lshlrev_b32 v206, 16, v183
    v_and_b32 v207, 0xffff0000, v183
    v_pk_fma_f32 v[192:193], v[200:201], v[190:191], v[192:193] op_sel_hi:[1,0,1]
    v_pk_fma_f32 v[194:195], v[202:203], v[190:191], v[194:195] op_sel_hi:[1,0,1]
    v_pk_fma_f32 v[196:197], v[204:205], v[190:191], v[196:197] op_sel_hi:[1,0,1]
    v_pk_fma_f32 v[198:199], v[206:207], v[190:191], v[198:199] op_sel_hi:[1,0,1]
    v_lshrrev_b32 v7, 4, v2
    v_lshl_add_u32 v7, v185, 3, v7
    v_permlane16_swap_b32 v192, v193
    v_permlane16_swap_b32 v194, v195
    v_permlane16_swap_b32 v196, v197
    v_permlane16_swap_b32 v198, v199
    v_add_f32 v192, v192, v193
    v_add_f32 v194, v194, v195
    v_add_f32 v196, v196, v197
    v_add_f32 v198, v198, v199
    v_and_b32 v6, 8, v0
    v_permlane32_swap_b32 v192, v194
    v_permlane32_swap_b32 v196, v198
    v_add_f32 v192, v192, v194
    v_add_f32 v196, v196, v198
    v_cmp_ne_u32 vcc, 0, v6
    v_add_f32_dpp v192, v192, v192 row_ror:8 row_mask:0xf bank_mask:0xf
    v_add_f32_dpp v196, v196, v196 row_ror:8 row_mask:0xf bank_mask:0xf
    v_lshrrev_b32 v6, 1, v6
    v_add_u32 v7, v7, v6
    v_cndmask_b32 v192, v192, v196, vcc
    v_and_b32 v6, 0xc0, v0
    v_add_lshl_u32 v7, v7, v6, 2
    ds_write_b32 v7, v192 offset:1024
    v_readfirstlane_b32 s5, v171
    s_nop 0
    s_add_u32 s5, s5, 0x9e3779b8
    s_or_b32 s5, s5, 1
    s_waitcnt vmcnt(4)
    v_mov_b32 v8, s5
    buffer_store_dword v8, v1, s[8:11], s66 offen sc1
    v_lshlrev_b32 v7, 2, v2
    v_add_u32 v7, 1024, v7
    v_lshlrev_b32 v6, 3, v2
    v_or_b32 v6, s64, v6
    s_waitcnt lgkmcnt(0)
    s_barrier
    s_cmp_lg_u32 s23, 0
    s_cbranch_scc1 k_nomod
    ds_read2st64_b32 v[8:9], v7 offset0:0 offset1:1
    ds_read2st64_b32 v[10:11], v7 offset0:2 offset1:3
    s_waitcnt lgkmcnt(0)
    v_pk_add_f32 v[8:9], v[8:9], v[10:11]
    v_add_f32 v8, v8, v9
    v_mov_b32 v9, s5
    buffer_store_dwordx2 v[8:9], v6, s[8:11], s67 offen sc1
k_nomod:
    s_add_u32 m0, s82, 0x4000
    s_add_u32 s42, s42, 57344
    buffer_load_dwordx4 v252, s[12:15], s42 offen offset:0 lds
    buffer_load_dwordx4 v255, s[12:15], s42 offen offset:1024 lds
    s_add_u32 m0, s82, 0x6000
    s_add_u32 s42, s42, 57344
    buffer_load_dwordx4 v252, s[12:15], s42 offen offset:0 lds
    buffer_load_dwordx4 v255, s[12:15], s42 offen offset:1024 lds
    s_mov_b32 s72, s54
    s_mov_b32 s73, s55
    s_mov_b32 s74, 1605632
    ds_read2_b32 a[96:97], v16 offset0:0 offset1:1
    s_and_b32 s3, s25, 3
    s_lshl2_add_u32 s43, s3, s23
    s_lshr_b32 s3, s24, 2
    ds_read2_b32 a[98:99], v16 offset0:2 offset1:3
    s_add_u32 m0, s82, 0x8000
    s_add_u32 s42, s42, 57344
    buffer_load_dwordx4 v252, s[12:15], s42 offen offset:0 lds
    s_mul_i32 s80, s3, 56
    s_and_b32 s3, s43, 14
    s_min_u32 s3, s3, 12
    ds_read2_b32 a[100:101], v16 offset0:128 offset1:129
    s_lshl2_add_u32 s80, s3, s80
    s_and_b32 s3, s24, 3
    s_lshl1_add_u32 s80, s3, s80
    ds_read2_b32 a[102:103], v16 offset0:130 offset1:131
    buffer_load_dwordx4 v255, s[12:15], s42 offen offset:1024 lds
    s_and_b32 s3, s43, 1
    s_add_u32 s80, s80, s3
    s_mul_i32 s80, s80, 14336
    ds_read2_b32 a[104:105], v17 offset0:0 offset1:1
    s_lshl_b32 s3, s29, 7
    s_add_u32 s80, s80, s3
    s_add_u32 s83, s80, 6144
    ds_read2_b32 a[106:107], v17 offset0:2 offset1:3
    s_add_u32 m0, s82, 0xa000
    s_add_u32 s42, s42, 57344
    buffer_load_dwordx4 v252, s[12:15], s42 offen offset:0 lds
    v_bfe_u32 v6, v2, 4, 1
    v_lshlrev_b32 v6, 2, v6
    v_xor_b32 v6, v6, v185
    ds_read2_b32 a[108:109], v17 offset0:128 offset1:129
    v_lshrrev_b32 v27, 3, v2
    v_mul_u32_u24 v27, 896, v27
    v_lshl_add_u32 v27, v6, 4, v27
    ds_read2_b32 a[110:111], v17 offset0:130 offset1:131
    buffer_load_dwordx4 v255, s[12:15], s42 offen offset:1024 lds
    s_lshl1_add_u32 s3, s27, s28
    s_lshl2_add_u32 s3, s3, s23
    s_lshl_b32 s55, s3, 9
    ds_read2_b32 a[112:113], v18 offset0:0 offset1:1
    s_add_u32 s55, s55, 6356992
    s_lshl_b32 s3, s3, 7
    s_add_u32 s3, s3, 6422528
    ds_read2_b32 a[114:115], v18 offset0:2 offset1:3
    s_add_u32 m0, s82, 0xc000
    s_add_u32 s42, s42, 57344
    buffer_load_dwordx4 v252, s[12:15], s42 offen offset:0 lds
    s_cmp_eq_u32 s6, 0
    s_cselect_b32 s3, s55, s3
    s_cselect_b32 s21, 32, 8
    ds_read2_b32 a[116:117], v18 offset0:128 offset1:129
    s_cmp_lt_u32 s6, 2
    s_cselect_b32 s21, s21, 0
    v_cmp_gt_u32 vcc, s21, v2
    ds_read2_b32 a[118:119], v18 offset0:130 offset1:131
    buffer_load_dwordx4 v255, s[12:15], s42 offen offset:1024 lds
    v_bfrev_b32 v6, 2
    s_nop 0
    v_cndmask_b32 v240, v6, v3, vcc
    ds_read2_b32 a[120:121], v19 offset0:0 offset1:1
    s_mov_b32 s48, s3
    s_lshr_b32 s3, s26, 5
    s_bfe_u32 s21, s26, 0x20002
    ds_read2_b32 a[122:123], v19 offset0:2 offset1:3
    s_add_u32 m0, s82, 0xe000
    s_add_u32 s42, s42, 57344
    buffer_load_dwordx4 v252, s[12:15], s42 offen offset:0 lds
    s_lshl2_add_u32 s3, s3, s21
    s_lshl1_add_u32 s3, s3, s34
    s_lshl_b32 s3, s3, 11
    ds_read2_b32 a[124:125], v19 offset0:128 offset1:129
    s_add_u32 s3, s3, 6553600
    v_and_b32 v7, 15, v2
    v_lshl_add_u32 v7, v7, 7, s3
    ds_read2_b32 a[126:127], v19 offset0:130 offset1:131
    buffer_load_dwordx4 v255, s[12:15], s42 offen offset:1024 lds
    s_lshl_b32 s3, s23, 9
    s_add_u32 s3, s3, 6815744
    v_bfe_u32 v8, v2, 2, 1
    ds_read2_b32 a[128:129], v16 offset0:16 offset1:17
    v_and_b32 v6, 3, v2
    v_lshl_add_u32 v6, v8, 4, v6
    v_cmp_gt_u32 vcc, 16, v2
    ds_read2_b32 a[130:131], v16 offset0:18 offset1:19
    s_add_u32 m0, s82, 0x10000
    s_add_u32 s42, s42, 57344
    buffer_load_dwordx4 v252, s[12:15], s42 offen offset:0 lds
    v_lshl_add_u32 v6, v6, 7, s3
    s_mul_i32 s3, s23, 224
    v_cndmask_b32 v7, v6, v7, vcc
    ds_read2_b32 a[132:133], v16 offset0:144 offset1:145
    s_add_u32 s3, s3, s26
    s_lshl_b32 s3, s3, 7
    s_add_u32 s30, s3, 6684672
    ds_read2_b32 a[134:135], v16 offset0:146 offset1:147
    buffer_load_dwordx4 v255, s[12:15], s42 offen offset:1024 lds
    v_bfe_u32 v4, v2, 2, 2
    v_lshrrev_b32 v8, 5, v2
    v_lshl_add_u32 v4, v8, 2, v4
    ds_read2_b32 a[136:137], v17 offset0:16 offset1:17
    v_lshlrev_b32 v4, 7, v4
    v_and_b32 v8, 3, v2
    v_lshl_add_u32 v4, v8, 3, v4
    ds_read2_b32 a[138:139], v17 offset0:18 offset1:19
    s_add_u32 m0, s82, 0x12000
    s_add_u32 s42, s42, 57344
    buffer_load_dwordx4 v252, s[12:15], s42 offen offset:0 lds
    v_bfe_u32 v8, v2, 4, 1
    v_lshl_add_u32 v4, v8, 5, v4
    v_bfe_u32 v8, v2, 3, 1
    ds_read2_b32 a[140:141], v17 offset0:144 offset1:145
    v_lshl_add_u32 v4, v8, 6, v4
    s_add_u32 s3, s82, 90112
    v_add_u32 v4, s3, v4
    ds_read2_b32 a[142:143], v17 offset0:146 offset1:147
    buffer_load_dwordx4 v255, s[12:15], s42 offen offset:1024 lds
    s_mul_i32 s3, s24, 14
    s_add_u32 s3, s3, s43
    s_mul_i32 s21, s29, 112
    ds_read2_b32 a[144:145], v18 offset0:16 offset1:17
    s_add_u32 s3, s3, s21
    s_lshl_b32 s66, s3, 11
    s_add_u32 s66, s66, 20971520
    ds_read2_b32 a[146:147], v18 offset0:18 offset1:19
    s_add_u32 m0, s82, 0x14000
    s_add_u32 s42, s42, 57344
    buffer_load_dwordx4 v252, s[12:15], s42 offen offset:0 lds
    s_lshl_b32 s67, s3, 7
    s_add_u32 s81, s67, 7208960
    s_mov_b32 s68, s8
    ds_read2_b32 a[148:149], v18 offset0:144 offset1:145
    s_mov_b32 s69, s9
    s_cmp_ge_u32 s43, 14
    s_cselect_b32 s70, 0, s10
    ds_read2_b32 a[150:151], v18 offset0:146 offset1:147
    buffer_load_dwordx4 v255, s[12:15], s42 offen offset:1024 lds
    ds_read2_b32 a[152:153], v19 offset0:16 offset1:17
    ds_read2_b32 a[154:155], v19 offset0:18 offset1:19
    ds_read2_b32 a[156:157], v19 offset0:144 offset1:145
    ds_read2_b32 a[158:159], v19 offset0:146 offset1:147
    s_add_u32 m0, s82, 0x16000
    s_add_u32 s42, s42, 57344
    buffer_load_dwordx4 v252, s[12:15], s42 offen offset:0 lds
    buffer_load_dwordx4 v255, s[12:15], s42 offen offset:1024 lds
    buffer_load_dword v6, v7, s[8:11], 0 offen sc1
    ds_read2_b32 a[160:161], v16 offset0:32 offset1:33
    ds_read2_b32 a[162:163], v16 offset0:34 offset1:35
    ds_read2_b32 a[164:165], v16 offset0:160 offset1:161
    ds_read2_b32 a[166:167], v16 offset0:162 offset1:163
    ds_read2_b32 a[168:169], v17 offset0:32 offset1:33
    ds_read2_b32 a[170:171], v17 offset0:34 offset1:35
    ds_read2_b32 a[172:173], v17 offset0:160 offset1:161
    ds_read2_b32 a[174:175], v17 offset0:162 offset1:163
    ds_read2_b32 a[176:177], v18 offset0:32 offset1:33
    ds_read2_b32 a[178:179], v18 offset0:34 offset1:35
    ds_read2_b32 a[180:181], v18 offset0:160 offset1:161
    ds_read2_b32 a[182:183], v18 offset0:162 offset1:163
    ds_read2_b32 a[184:185], v19 offset0:32 offset1:33
    ds_read2_b32 a[186:187], v19 offset0:34 offset1:35
    ds_read2_b32 a[188:189], v19 offset0:160 offset1:161
    ds_read2_b32 a[190:191], v19 offset0:162 offset1:163
    ds_read2_b32 a[192:193], v16 offset0:48 offset1:49
    ds_read2_b32 a[194:195], v16 offset0:50 offset1:51
    ds_read2_b32 a[196:197], v16 offset0:176 offset1:177
    ds_read2_b32 a[198:199], v16 offset0:178 offset1:179
    ds_read2_b32 a[200:201], v17 offset0:48 offset1:49
    ds_read2_b32 a[202:203], v17 offset0:50 offset1:51
    ds_read2_b32 a[204:205], v17 offset0:176 offset1:177
    ds_read2_b32 a[206:207], v17 offset0:178 offset1:179
    s_waitcnt vmcnt(9)
    s_barrier
    ds_read_b64_tr_b16 a[0:1], v253 offset:0
    ds_read_b64_tr_b16 a[2:3], v253 offset:1024
    ds_read_b64_tr_b16 a[4:5], v254 offset:0
    ds_read_b64_tr_b16 a[6:7], v254 offset:1024
    ds_read_b64_tr_b16 a[8:9], v253 offset:8192
    ds_read_b64_tr_b16 a[10:11], v253 offset:9216
    ds_read_b64_tr_b16 a[12:13], v254 offset:8192
    ds_read_b64_tr_b16 a[14:15], v254 offset:9216
    ds_read_b64_tr_b16 a[16:17], v253 offset:16384
    ds_read_b64_tr_b16 a[18:19], v253 offset:17408
    ds_read_b64_tr_b16 a[20:21], v254 offset:16384
    ds_read_b64_tr_b16 a[22:23], v254 offset:17408
    ds_read_b64_tr_b16 a[24:25], v253 offset:24576
    ds_read_b64_tr_b16 a[26:27], v253 offset:25600
    ds_read_b64_tr_b16 a[28:29], v254 offset:24576
    ds_read_b64_tr_b16 a[30:31], v254 offset:25600
    ds_read_b64_tr_b16 a[32:33], v253 offset:32768
    ds_read_b64_tr_b16 a[34:35], v253 offset:33792
    ds_read_b64_tr_b16 a[36:37], v254 offset:32768
    ds_read_b64_tr_b16 a[38:39], v254 offset:33792
    ds_read_b64_tr_b16 a[40:41], v253 offset:40960
    ds_read_b64_tr_b16 a[42:43], v253 offset:41984
    ds_read_b64_tr_b16 a[44:45], v254 offset:40960
    ds_read_b64_tr_b16 a[46:47], v254 offset:41984
    ds_read_b64_tr_b16 a[48:49], v253 offset:49152
    ds_read_b64_tr_b16 a[50:51], v253 offset:50176
    ds_read_b64_tr_b16 a[52:53], v254 offset:49152
    ds_read_b64_tr_b16 a[54:55], v254 offset:50176
    ds_read_b64_tr_b16 a[56:57], v253 offset:57344
    ds_read_b64_tr_b16 a[58:59], v253 offset:58368
    ds_read_b64_tr_b16 a[60:61], v254 offset:57344
    ds_read_b64_tr_b16 a[62:63], v254 offset:58368
    s_waitcnt vmcnt(0)
    v_cmp_ne_u32 vcc, s5, v6
    s_nop 4
    s_cbranch_vccz k_h1_go
    s_mov_b32 s22, 400000
k_h1_spin:
    buffer_load_dword v6, v7, s[8:11], 0 offen sc1
    s_waitcnt vmcnt(0)
    v_cmp_ne_u32 vcc, s5, v6
    s_nop 4
    s_cbranch_vccz k_h1_go
    s_sub_u32 s22, s22, 1
    s_cmp_lg_u32 s22, 0
    s_cbranch_scc1 k_h1_spin
k_h1_go:
    s_mov_b32 m0, s65
    s_nop 0
    buffer_load_dwordx4 v3, s[8:11], s32 offen sc1 lds
    buffer_load_dwordx4 v3, s[8:11], s32 offen offset:1024 sc1 lds
    s_barrier
    buffer_load_dwordx4 v[196:199], v248, s[8:11], s39 offen offset:2048 sc1
    buffer_load_dwordx4 v[192:195], v248, s[8:11], s39 offen offset:0 sc1
    buffer_load_dwordx4 v[200:203], v249, s[8:11], s37 offen offset:0 sc1
    buffer_load_dwordx4 v[216:219], v249, s[8:11], s37 offen offset:256 sc1
    buffer_load_dwordx4 v[204:207], v249, s[8:11], s37 offen offset:128 sc1
    buffer_load_dwordx4 v[220:223], v249, s[8:11], s37 offen offset:384 sc1
    buffer_load_dwordx4 v[208:211], v249, s[8:11], s38 offen offset:0 sc1
    buffer_load_dwordx4 v[224:227], v249, s[8:11], s38 offen offset:256 sc1
    buffer_load_dwordx4 v[212:215], v249, s[8:11], s38 offen offset:128 sc1
    buffer_load_dwordx4 v[228:231], v249, s[8:11], s38 offen offset:384 sc1
    buffer_store_dwordx4 v[12:15], v240, s[8:11], s48 offen sc1
    v_xor_b32 v7, 64, v4
    v_add_u32 v253, 0x10000, v253
    v_add_u32 v254, 0x10000, v254
    ds_read_b64_tr_b16 a[64:65], v253 offset:0
    ds_read_b64_tr_b16 a[66:67], v253 offset:1024
    ds_read_b64_tr_b16 a[68:69], v254 offset:0
    ds_read_b64_tr_b16 a[70:71], v254 offset:1024
    ds_read_b64_tr_b16 a[72:73], v253 offset:8192
    ds_read_b64_tr_b16 a[74:75], v253 offset:9216
    ds_read_b64_tr_b16 a[76:77], v254 offset:8192
    ds_read_b64_tr_b16 a[78:79], v254 offset:9216
    ds_read_b64_tr_b16 a[80:81], v253 offset:16384
    ds_read_b64_tr_b16 a[82:83], v253 offset:17408
    ds_read_b64_tr_b16 a[84:85], v254 offset:16384
    ds_read_b64_tr_b16 a[86:87], v254 offset:17408
    ds_read_b64_tr_b16 a[88:89], v253 offset:24576
    ds_read_b64_tr_b16 a[90:91], v253 offset:25600
    ds_read_b64_tr_b16 a[92:93], v254 offset:24576
    ds_read_b64_tr_b16 a[94:95], v254 offset:25600
    v_add_u32 v253, 0xffff0000, v253
    v_add_u32 v254, 0xffff0000, v254
    ds_read2_b32 a[208:209], v18 offset0:48 offset1:49
    ds_read2_b32 a[210:211], v18 offset0:50 offset1:51
    ds_read2_b32 a[212:213], v18 offset0:176 offset1:177
    ds_read2_b32 a[214:215], v18 offset0:178 offset1:179
    ds_read2_b32 a[216:217], v19 offset0:48 offset1:49
    ds_read2_b32 a[218:219], v19 offset0:50 offset1:51
    ds_read2_b32 a[220:221], v19 offset0:176 offset1:177
    ds_read2_b32 a[222:223], v19 offset0:178 offset1:179
    s_waitcnt vmcnt(11)
    s_waitcnt lgkmcnt(0)
    s_barrier
    ds_read_b128 v[64:67], v20 offset:192
    ds_read_b128 v[96:99], v20 offset:128
    ds_read_b128 v[128:131], v20 offset:64
    ds_read_b128 v[160:163], v20 offset:0
    ds_read_b128 v[68:71], v20 offset:704
    ds_read_b128 v[100:103], v20 offset:640
    ds_read_b128 v[132:135], v20 offset:576
    ds_read_b128 v[164:167], v20 offset:512
    ds_read_b128 v[72:75], v20 offset:1216
    ds_read_b128 v[104:107], v20 offset:1152
    s_waitcnt lgkmcnt(9)
    v_mfma_f32_16x16x32_bf16 v[32:35], a[96:99], v[64:67], 0
    ds_read_b128 v[136:139], v20 offset:1088
    buffer_load_dwordx4 v[8:11], v5, s[8:11], s31 offen sc1
    s_waitcnt lgkmcnt(9)
    v_mfma_f32_16x16x32_bf16 v[32:35], a[128:131], v[96:99], v[32:35]
    ds_read_b128 v[168:171], v20 offset:1024
    ds_read_b128 v[16:19], v23 offset:0
    ds_read_b128 v[12:15], v23 offset:2048
    s_waitcnt lgkmcnt(10)
    v_mfma_f32_16x16x32_bf16 v[32:35], a[160:163], v[128:131], v[32:35]
    ds_read_b128 v[76:79], v20 offset:1728
    v_mfma_f32_16x16x32_bf16 v[32:35], a[192:195], v[160:163], v[32:35]
    ds_read_b128 v[108:111], v20 offset:1664
    s_add_u32 m0, s82, 0x0
    s_add_u32 s42, s42, 57344
    buffer_load_dwordx4 v252, s[12:15], s42 offen offset:0 lds
    v_mfma_f32_16x16x32_bf16 v[36:39], a[100:103], v[64:67], 0
    ds_read_b128 v[140:143], v20 offset:1600
    v_mfma_f32_16x16x32_bf16 v[36:39], a[132:135], v[96:99], v[36:39]
    ds_read_b128 v[172:175], v20 offset:1536
    v_mfma_f32_16x16x32_bf16 v[36:39], a[164:167], v[128:131], v[36:39]
    ds_read_b128 v[80:83], v20 offset:2240
    buffer_load_dwordx4 v255, s[12:15], s42 offen offset:1024 lds
    v_mfma_f32_16x16x32_bf16 v[36:39], a[196:199], v[160:163], v[36:39]
    ds_read_b128 v[84:87], v20 offset:2752
    s_waitcnt lgkmcnt(12)
    v_mfma_f32_16x16x32_bf16 v[36:39], a[96:99], v[68:71], v[36:39]
    ds_read_b128 v[88:91], v20 offset:3264
    v_mfma_f32_16x16x32_bf16 v[36:39], a[128:131], v[100:103], v[36:39]
    ds_read_b128 v[92:95], v20 offset:3776
    s_add_u32 m0, s82, 0x2000
    s_add_u32 s42, s42, 57344
    buffer_load_dwordx4 v252, s[12:15], s42 offen offset:0 lds
    v_mfma_f32_16x16x32_bf16 v[36:39], a[160:163], v[132:135], v[36:39]
    ds_read_b128 v[112:115], v20 offset:2176
    ds_write_b128 v21, v[32:35] offset:0
    v_mfma_f32_16x16x32_bf16 v[36:39], a[192:195], v[164:167], v[36:39]
    ds_read_b128 v[116:119], v20 offset:2688
    v_mfma_f32_16x16x32_bf16 v[40:43], a[104:107], v[64:67], 0
    ds_read_b128 v[120:123], v20 offset:3200
    buffer_load_dwordx4 v255, s[12:15], s42 offen offset:1024 lds
    v_mfma_f32_16x16x32_bf16 v[40:43], a[136:139], v[96:99], v[40:43]
    ds_read_b128 v[124:127], v20 offset:3712
    v_mfma_f32_16x16x32_bf16 v[40:43], a[168:171], v[128:131], v[40:43]
    ds_read_b128 v[144:147], v20 offset:2112
    s_waitcnt vmcnt(6)
    v_lshlrev_b32 v232, 16, v192
    v_mfma_f32_16x16x32_bf16 v[40:43], a[200:203], v[160:163], v[40:43]
    ds_read_b128 v[148:151], v20 offset:2624
    s_add_u32 m0, s82, 0x4000
    s_add_u32 s42, s42, 57344
    buffer_load_dwordx4 v252, s[12:15], s42 offen offset:0 lds
    v_mfma_f32_16x16x32_bf16 v[40:43], a[100:103], v[68:71], v[40:43]
    ds_read_b128 v[152:155], v20 offset:3136
    v_and_b32 v233, 0xffff0000, v192
    v_lshlrev_b32 v234, 16, v193
    v_mfma_f32_16x16x32_bf16 v[40:43], a[132:135], v[100:103], v[40:43]
    ds_read_b128 v[156:159], v20 offset:3648
    v_and_b32 v235, 0xffff0000, v193
    v_lshlrev_b32 v236, 16, v194
    v_mfma_f32_16x16x32_bf16 v[40:43], a[164:167], v[132:135], v[40:43]
    ds_read_b128 v[176:179], v20 offset:2048
    ds_write_b128 v21, v[36:39] offset:1024
    buffer_load_dwordx4 v255, s[12:15], s42 offen offset:1024 lds
    v_mfma_f32_16x16x32_bf16 v[40:43], a[196:199], v[164:167], v[40:43]
    ds_read_b128 v[180:183], v20 offset:2560
    v_and_b32 v237, 0xffff0000, v194
    v_lshlrev_b32 v238, 16, v195
    s_waitcnt lgkmcnt(14)
    v_mfma_f32_16x16x32_bf16 v[40:43], a[96:99], v[72:75], v[40:43]
    ds_read_b128 v[184:187], v20 offset:3072
    v_and_b32 v239, 0xffff0000, v195
    v_fma_f32 v200, v232, v200, v216
    v_mfma_f32_16x16x32_bf16 v[40:43], a[128:131], v[104:107], v[40:43]
    ds_read_b128 v[188:191], v20 offset:3584
    s_add_u32 m0, s82, 0x6000
    s_add_u32 s42, s42, 57344
    buffer_load_dwordx4 v252, s[12:15], s42 offen offset:0 lds
    v_mfma_f32_16x16x32_bf16 v[40:43], a[160:163], v[136:139], v[40:43]
    v_fma_f32 v201, v233, v201, v217
    v_fma_f32 v202, v234, v202, v218
    v_fma_f32 v203, v235, v203, v219
    v_mfma_f32_16x16x32_bf16 v[40:43], a[192:195], v[168:171], v[40:43]
    v_fma_f32 v204, v236, v204, v220
    v_fma_f32 v205, v237, v205, v221
    v_fma_f32 v206, v238, v206, v222
    v_mfma_f32_16x16x32_bf16 v[44:47], a[108:111], v[64:67], 0
    buffer_load_dwordx4 v255, s[12:15], s42 offen offset:1024 lds
    v_mfma_f32_16x16x32_bf16 v[44:47], a[140:143], v[96:99], v[44:47]
    v_fma_f32 v207, v239, v207, v223
    v_lshlrev_b32 v223, 16, v16
    v_and_b32 v222, 0xffff0000, v16
    v_mfma_f32_16x16x32_bf16 v[44:47], a[172:175], v[128:131], v[44:47]
    v_lshlrev_b32 v221, 16, v17
    v_and_b32 v220, 0xffff0000, v17
    v_lshlrev_b32 v219, 16, v18
    v_mfma_f32_16x16x32_bf16 v[44:47], a[204:207], v[160:163], v[44:47]
    v_and_b32 v218, 0xffff0000, v18
    v_lshlrev_b32 v217, 16, v19
    v_and_b32 v216, 0xffff0000, v19
    v_mfma_f32_16x16x32_bf16 v[44:47], a[104:107], v[68:71], v[44:47]
    s_add_u32 m0, s82, 0x8000
    s_add_u32 s42, s42, 57344
    buffer_load_dwordx4 v252, s[12:15], s42 offen offset:0 lds
    v_mfma_f32_16x16x32_bf16 v[44:47], a[136:139], v[100:103], v[44:47]
    s_nop 0
    v_mfma_f32_16x16x32_bf16 v[44:47], a[168:171], v[132:135], v[44:47]
    ds_write_b128 v21, v[40:43] offset:2048
    v_mfma_f32_16x16x32_bf16 v[44:47], a[200:203], v[164:167], v[44:47]
    s_waitcnt vmcnt(9)
    v_cmp_ne_u32 vcc, s5, v9
    v_cmp_ne_u32 s[76:77], s5, v11
    s_nop 0
    s_or_b64 vcc, vcc, s[76:77]
    s_and_b32 vcc_lo, vcc_lo, 0x001f1f1f
    s_and_b32 vcc_hi, vcc_hi, 0x1f
    s_or_b32 s3, vcc_lo, vcc_hi
    s_cbranch_scc1 k_slow_mod
k_ok_mod:
    v_mov_b32 v9, v10
    v_mfma_f32_16x16x32_bf16 v[44:47], a[100:103], v[72:75], v[44:47]
    buffer_load_dwordx4 v255, s[12:15], s42 offen offset:1024 lds
    v_mfma_f32_16x16x32_bf16 v[44:47], a[132:135], v[104:107], v[44:47]
    s_nop 0
    s_nop 0
    v_add_f32_dpp v8, v8, v8 quad_perm:[1,0,3,2] row_mask:0xf bank_mask:0xf
    v_mfma_f32_16x16x32_bf16 v[44:47], a[164:167], v[136:139], v[44:47]
    v_add_f32_dpp v9, v9, v9 quad_perm:[1,0,3,2] row_mask:0xf bank_mask:0xf
    s_nop 0
    v_add_f32_dpp v8, v8, v8 quad_perm:[2,3,0,1] row_mask:0xf bank_mask:0xf
    v_mfma_f32_16x16x32_bf16 v[44:47], a[196:199], v[168:171], v[44:47]
    v_add_f32_dpp v9, v9, v9 quad_perm:[2,3,0,1] row_mask:0xf bank_mask:0xf
    s_nop 0
    v_add_f32_dpp v8, v8, v8 row_half_mirror row_mask:0xf bank_mask:0xf
    v_mfma_f32_16x16x32_bf16 v[44:47], a[96:99], v[76:79], v[44:47]
    s_add_u32 m0, s82, 0xa000
    s_add_u32 s42, s42, 57344
    buffer_load_dwordx4 v252, s[12:15], s42 offen offset:0 lds
    v_mfma_f32_16x16x32_bf16 v[44:47], a[128:131], v[108:111], v[44:47]
    v_add_f32_dpp v9, v9, v9 row_half_mirror row_mask:0xf bank_mask:0xf
    v_cvt_pk_bf16_f32 v8, v8, v9
    v_lshlrev_b32 v30, v25, s20
    v_mfma_f32_16x16x32_bf16 v[44:47], a[160:163], v[140:143], v[44:47]
    v_readlane_b32 s44, v8, 0
    v_readlane_b32 s45, v8, 8
    v_readlane_b32 s46, v8, 16
    v_mfma_f32_16x16x32_bf16 v[44:47], a[192:195], v[172:175], v[44:47]
    v_readlane_b32 s47, v8, 32
    v_and_b32 v30, 0xffff0000, v30
    v_lshlrev_b32 v8, v25, s44
    v_mfma_f32_16x16x32_bf16 v[48:51], a[112:115], v[64:67], 0
    buffer_load_dwordx4 v255, s[12:15], s42 offen offset:1024 lds
    v_mfma_f32_16x16x32_bf16 v[52:55], a[116:119], v[64:67], 0
    v_lshlrev_b32 v9, v25, s45
    v_lshlrev_b32 v10, v25, s46
    v_lshlrev_b32 v11, v25, s47
    v_mfma_f32_16x16x32_bf16 v[56:59], a[120:123], v[64:67], 0
    v_and_b32 v8, 0xffff0000, v8
    v_and_b32 v9, 0xffff0000, v9
    v_and_b32 v10, 0xffff0000, v10
    v_mfma_f32_16x16x32_bf16 v[60:63], a[124:127], v[64:67], 0
    v_and_b32 v11, 0xffff0000, v11
    v_add_f32 v9, 1.0, v9
    v_add_f32 v11, 1.0, v11
    v_mfma_f32_16x16x32_bf16 v[48:51], a[108:111], v[68:71], v[48:51]
    s_add_u32 m0, s82, 0xc000
    s_add_u32 s42, s42, 57344
    buffer_load_dwordx4 v252, s[12:15], s42 offen offset:0 lds
    v_mfma_f32_16x16x32_bf16 v[52:55], a[112:115], v[68:71], v[52:55]
    v_mul_f32 v29, v10, v8
    v_cvt_pk_bf16_f32 v9, v9, v11
    v_and_b32 v250, 0xffff0000, v9
    v_mfma_f32_16x16x32_bf16 v[56:59], a[116:119], v[68:71], v[56:59]
    ds_write_b128 v21, v[44:47] offset:3072
    v_mfma_f32_16x16x32_bf16 v[60:63], a[120:123], v[68:71], v[60:63]
    v_lshlrev_b32 v9, 16, v9
    v_mul_f32 v28, v10, v9
    v_mfma_f32_16x16x32_bf16 v[48:51], a[104:107], v[72:75], v[48:51]
    buffer_load_dwordx4 v255, s[12:15], s42 offen offset:1024 lds
    v_mfma_f32_16x16x32_bf16 v[52:55], a[108:111], v[72:75], v[52:55]
    s_waitcnt vmcnt(6)
    s_waitcnt lgkmcnt(0)
    s_barrier
    ds_read_b128 v[32:35], v22 offset:0
    v_mfma_f32_16x16x32_bf16 v[56:59], a[112:115], v[72:75], v[56:59]
    ds_read_b128 v[40:43], v22 offset:8192
    ds_read_b128 v[36:39], v26 offset:0
    ds_read_b128 v[44:47], v26 offset:8192
    v_fma_f32 v200, v200, v28, v29
    v_mfma_f32_16x16x32_bf16 v[60:63], a[116:119], v[72:75], v[60:63]
    v_fma_f32 v201, v201, v28, v29
    v_fma_f32 v202, v202, v28, v29
    v_fma_f32 v203, v203, v28, v29
    v_fma_f32 v204, v204, v28, v29
    v_mfma_f32_16x16x32_bf16 v[48:51], a[100:103], v[76:79], v[48:51]
    s_add_u32 m0, s82, 0xe000
    s_add_u32 s42, s42, 57344
    buffer_load_dwordx4 v252, s[12:15], s42 offen offset:0 lds
    v_mfma_f32_16x16x32_bf16 v[52:55], a[104:107], v[76:79], v[52:55]
    v_fma_f32 v205, v205, v28, v29
    v_fma_f32 v206, v206, v28, v29
    v_fma_f32 v207, v207, v28, v29
    s_waitcnt lgkmcnt(2)
    v_mfma_f32_16x16x32_bf16 v[56:59], a[108:111], v[76:79], v[56:59]
    v_add_f32 v32, v32, v40
    v_add_f32 v33, v33, v41
    v_add_f32 v34, v34, v42
    v_add_f32 v35, v35, v43
    v_mfma_f32_16x16x32_bf16 v[60:63], a[112:115], v[76:79], v[60:63]
    v_fma_f32 v32, v216, v30, v32
    v_fma_f32 v33, v217, v30, v33
    v_fma_f32 v34, v218, v30, v34
    v_fma_f32 v35, v219, v30, v35
    v_mfma_f32_16x16x32_bf16 v[48:51], a[96:99], v[80:83], v[48:51]
    buffer_load_dwordx4 v255, s[12:15], s42 offen offset:1024 lds
    v_fma_f32 v32, v200, v32, v232
    v_mfma_f32_16x16x32_bf16 v[52:55], a[100:103], v[80:83], v[52:55]
    v_fma_f32 v33, v201, v33, v233
    v_fma_f32 v34, v202, v34, v234
    v_fma_f32 v35, v203, v35, v235
    v_cvt_pk_bf16_f32 v16, v32, v33
    v_mfma_f32_16x16x32_bf16 v[56:59], a[104:107], v[80:83], v[56:59]
    v_cvt_pk_bf16_f32 v17, v34, v35
    v_mul_f32 v32, v32, v250
    v_mul_f32 v33, v33, v250
    v_mul_f32 v34, v34, v250
    v_mfma_f32_16x16x32_bf16 v[60:63], a[108:111], v[80:83], v[60:63]
    v_mul_f32 v35, v35, v250
    v_cvt_pk_bf16_f32 v192, v32, v33
    v_cvt_pk_bf16_f32 v193, v34, v35
    s_waitcnt lgkmcnt(0)
    v_mfma_f32_16x16x32_bf16 v[52:55], a[96:99], v[84:87], v[52:55]
    s_add_u32 m0, s82, 0x10000
    s_add_u32 s42, s42, 57344
    buffer_load_dwordx4 v252, s[12:15], s42 offen offset:0 lds
    v_mfma_f32_16x16x32_bf16 v[56:59], a[100:103], v[84:87], v[56:59]
    v_add_f32 v36, v36, v44
    v_add_f32 v37, v37, v45
    v_add_f32 v38, v38, v46
    v_add_f32 v39, v39, v47
    v_mfma_f32_16x16x32_bf16 v[60:63], a[104:107], v[84:87], v[60:63]
    v_fma_f32 v36, v220, v30, v36
    v_fma_f32 v37, v221, v30, v37
    v_fma_f32 v38, v222, v30, v38
    v_fma_f32 v39, v223, v30, v39
    v_mfma_f32_16x16x32_bf16 v[56:59], a[96:99], v[88:91], v[56:59]
    v_fma_f32 v36, v204, v36, v236
    v_fma_f32 v37, v205, v37, v237
    v_fma_f32 v38, v206, v38, v238
    v_fma_f32 v39, v207, v39, v239
    v_mfma_f32_16x16x32_bf16 v[60:63], a[100:103], v[88:91], v[60:63]
    buffer_load_dwordx4 v255, s[12:15], s42 offen offset:1024 lds
    v_cvt_pk_bf16_f32 v18, v36, v37
    v_mfma_f32_16x16x32_bf16 v[60:63], a[96:99], v[92:95], v[60:63]
    v_cvt_pk_bf16_f32 v19, v38, v39
    v_mul_f32 v36, v36, v250
    v_mul_f32 v37, v37, v250
    v_mul_f32 v38, v38, v250
    v_mfma_f32_16x16x32_bf16 v[48:51], a[144:147], v[96:99], v[48:51]
    v_mul_f32 v39, v39, v250
    v_cvt_pk_bf16_f32 v194, v36, v37
    v_cvt_pk_bf16_f32 v195, v38, v39
    buffer_store_dwordx4 v[192:195], v24, s[8:11], s40 offen sc1
    v_mfma_f32_16x16x32_bf16 v[48:51], a[140:143], v[100:103], v[48:51]
    buffer_store_dwordx4 v[16:19], v24, s[8:11], s41 offen sc1
    v_mfma_f32_16x16x32_bf16 v[48:51], a[136:139], v[104:107], v[48:51]
    s_add_u32 m0, s82, 0x12000
    s_add_u32 s42, s42, 57344
    buffer_load_dwordx4 v252, s[12:15], s42 offen offset:0 lds
    v_mfma_f32_16x16x32_bf16 v[48:51], a[132:135], v[108:111], v[48:51]
    s_add_u32 s40, s40, 917504
    s_add_u32 s41, s41, 917504
    v_mfma_f32_16x16x32_bf16 v[48:51], a[128:131], v[112:115], v[48:51]
    v_mov_b32 v251, v250
    v_mov_b32 v31, v30
    v_mfma_f32_16x16x32_bf16 v[48:51], a[176:179], v[128:131], v[48:51]
    v_lshlrev_b32 v240, 16, v196
    v_and_b32 v241, 0xffff0000, v196
    v_mfma_f32_16x16x32_bf16 v[48:51], a[172:175], v[132:135], v[48:51]
    buffer_load_dwordx4 v255, s[12:15], s42 offen offset:1024 lds
    v_mfma_f32_16x16x32_bf16 v[48:51], a[168:171], v[136:139], v[48:51]
    v_lshlrev_b32 v242, 16, v197
    v_and_b32 v243, 0xffff0000, v197
    v_mfma_f32_16x16x32_bf16 v[48:51], a[164:167], v[140:143], v[48:51]
    v_lshlrev_b32 v244, 16, v198
    v_and_b32 v245, 0xffff0000, v198
    v_mfma_f32_16x16x32_bf16 v[48:51], a[160:163], v[144:147], v[48:51]
    v_lshlrev_b32 v246, 16, v199
    v_and_b32 v247, 0xffff0000, v199
    v_mfma_f32_16x16x32_bf16 v[48:51], a[208:211], v[160:163], v[48:51]
    s_add_u32 m0, s82, 0x14000
    s_add_u32 s42, s42, 57344
    buffer_load_dwordx4 v252, s[12:15], s42 offen offset:0 lds
    v_mfma_f32_16x16x32_bf16 v[48:51], a[204:207], v[164:167], v[48:51]
    v_fma_f32 v208, v240, v208, v224
    v_fma_f32 v209, v241, v209, v225
    v_mfma_f32_16x16x32_bf16 v[48:51], a[200:203], v[168:171], v[48:51]
    v_fma_f32 v210, v242, v210, v226
    v_fma_f32 v211, v243, v211, v227
    v_mfma_f32_16x16x32_bf16 v[48:51], a[196:199], v[172:175], v[48:51]
    v_fma_f32 v212, v244, v212, v228
    v_fma_f32 v213, v245, v213, v229
    v_mfma_f32_16x16x32_bf16 v[48:51], a[192:195], v[176:179], v[48:51]
    buffer_load_dwordx4 v255, s[12:15], s42 offen offset:1024 lds
    v_mfma_f32_16x16x32_bf16 v[52:55], a[148:151], v[96:99], v[52:55]
    v_fma_f32 v214, v246, v214, v230
    v_fma_f32 v215, v247, v215, v231
    v_mfma_f32_16x16x32_bf16 v[52:55], a[144:147], v[100:103], v[52:55]
    v_fma_f32 v208, v208, v28, v29
    v_fma_f32 v209, v209, v28, v29
    v_mfma_f32_16x16x32_bf16 v[52:55], a[140:143], v[104:107], v[52:55]
    v_fma_f32 v210, v210, v28, v29
    v_fma_f32 v211, v211, v28, v29
    v_mfma_f32_16x16x32_bf16 v[52:55], a[136:139], v[108:111], v[52:55]
    s_add_u32 m0, s82, 0xffff2400
    s_add_u32 s42, s42, 57344
    buffer_load_dwordx4 v252, s[12:15], s42 offen offset:0 lds
    v_mfma_f32_16x16x32_bf16 v[52:55], a[132:135], v[112:115], v[52:55]
    v_fma_f32 v212, v212, v28, v29
    v_fma_f32 v213, v213, v28, v29
    v_mfma_f32_16x16x32_bf16 v[52:55], a[128:131], v[116:119], v[52:55]
    v_fma_f32 v214, v214, v28, v29
    v_fma_f32 v215, v215, v28, v29
    v_mfma_f32_16x16x32_bf16 v[52:55], a[180:183], v[128:131], v[52:55]
    ds_write_b128 v21, v[48:51] offset:4096
    v_mfma_f32_16x16x32_bf16 v[52:55], a[176:179], v[132:135], v[52:55]
    buffer_load_dwordx4 v255, s[12:15], s42 offen offset:1024 lds
    v_mfma_f32_16x16x32_bf16 v[52:55], a[172:175], v[136:139], v[52:55]
    v_lshlrev_b32 v231, 16, v12
    v_and_b32 v230, 0xffff0000, v12
    v_mfma_f32_16x16x32_bf16 v[52:55], a[168:171], v[140:143], v[52:55]
    v_lshlrev_b32 v229, 16, v13
    v_and_b32 v228, 0xffff0000, v13
    v_mfma_f32_16x16x32_bf16 v[52:55], a[164:167], v[144:147], v[52:55]
    v_lshlrev_b32 v227, 16, v14
    v_and_b32 v226, 0xffff0000, v14
    v_mfma_f32_16x16x32_bf16 v[52:55], a[160:163], v[148:151], v[52:55]
    v_lshlrev_b32 v225, 16, v15
    v_and_b32 v224, 0xffff0000, v15
    v_mfma_f32_16x16x32_bf16 v[52:55], a[212:215], v[160:163], v[52:55]
    ds_read_b64_tr_b16 a[96:97], v253 offset:0
    ds_read_b64_tr_b16 a[98:99], v253 offset:1024
    v_mfma_f32_16x16x32_bf16 v[52:55], a[208:211], v[164:167], v[52:55]
    ds_read_b64_tr_b16 a[100:101], v254 offset:0
    ds_read_b64_tr_b16 a[102:103], v254 offset:1024
    v_mfma_f32_16x16x32_bf16 v[52:55], a[204:207], v[168:171], v[52:55]
    ds_read_b64_tr_b16 a[104:105], v253 offset:8192
    ds_read_b64_tr_b16 a[106:107], v253 offset:9216
    v_mfma_f32_16x16x32_bf16 v[52:55], a[200:203], v[172:175], v[52:55]
    ds_read_b64_tr_b16 a[108:109], v254 offset:8192
    ds_read_b64_tr_b16 a[110:111], v254 offset:9216
    v_mfma_f32_16x16x32_bf16 v[52:55], a[196:199], v[176:179], v[52:55]
    ds_read_b64_tr_b16 a[112:113], v253 offset:16384
    ds_read_b64_tr_b16 a[114:115], v253 offset:17408
    v_mfma_f32_16x16x32_bf16 v[52:55], a[192:195], v[180:183], v[52:55]
    ds_read_b64_tr_b16 a[116:117], v254 offset:16384
    ds_read_b64_tr_b16 a[118:119], v254 offset:17408
    v_mfma_f32_16x16x32_bf16 v[56:59], a[152:155], v[96:99], v[56:59]
    ds_read_b64_tr_b16 a[120:121], v253 offset:24576
    ds_read_b64_tr_b16 a[122:123], v253 offset:25600
    v_mfma_f32_16x16x32_bf16 v[56:59], a[148:151], v[100:103], v[56:59]
    ds_read_b64_tr_b16 a[124:125], v254 offset:24576
    ds_read_b64_tr_b16 a[126:127], v254 offset:25600
    v_mfma_f32_16x16x32_bf16 v[56:59], a[144:147], v[104:107], v[56:59]
    v_mfma_f32_16x16x32_bf16 v[56:59], a[140:143], v[108:111], v[56:59]
    v_mfma_f32_16x16x32_bf16 v[56:59], a[136:139], v[112:115], v[56:59]
    s_nop 0
    v_mfma_f32_16x16x32_bf16 v[56:59], a[132:135], v[116:119], v[56:59]
    s_nop 0
    v_mfma_f32_16x16x32_bf16 v[56:59], a[128:131], v[120:123], v[56:59]
    ds_write_b128 v21, v[52:55] offset:5120
    v_mfma_f32_16x16x32_bf16 v[56:59], a[184:187], v[128:131], v[56:59]
    v_mfma_f32_16x16x32_bf16 v[56:59], a[180:183], v[132:135], v[56:59]
    v_mfma_f32_16x16x32_bf16 v[56:59], a[176:179], v[136:139], v[56:59]
    v_mfma_f32_16x16x32_bf16 v[56:59], a[172:175], v[140:143], v[56:59]
    v_mfma_f32_16x16x32_bf16 v[56:59], a[168:171], v[144:147], v[56:59]
    s_add_u32 m0, s82, 90112
    s_nop 0
    buffer_load_dwordx4 v27, s[72:75], s80 offen lds
    v_mfma_f32_16x16x32_bf16 v[56:59], a[164:167], v[148:151], v[56:59]
    v_mfma_f32_16x16x32_bf16 v[56:59], a[160:163], v[152:155], v[56:59]
    buffer_load_dwordx4 v27, s[72:75], s83 offen offset:1024 lds
    v_mfma_f32_16x16x32_bf16 v[56:59], a[216:219], v[160:163], v[56:59]
    v_mfma_f32_16x16x32_bf16 v[56:59], a[212:215], v[164:167], v[56:59]
    v_mfma_f32_16x16x32_bf16 v[56:59], a[208:211], v[168:171], v[56:59]
    v_mfma_f32_16x16x32_bf16 v[56:59], a[204:207], v[172:175], v[56:59]
    v_mfma_f32_16x16x32_bf16 v[56:59], a[200:203], v[176:179], v[56:59]
    v_mfma_f32_16x16x32_bf16 v[56:59], a[196:199], v[180:183], v[56:59]
    s_waitcnt vmcnt(8)
    v_mov_b32 v6, s5
    buffer_store_dword v6, v1, s[8:11], s30 offen sc1
    v_mfma_f32_16x16x32_bf16 v[56:59], a[192:195], v[184:187], v[56:59]
    v_mfma_f32_16x16x32_bf16 v[60:63], a[156:159], v[96:99], v[60:63]
    v_mfma_f32_16x16x32_bf16 v[60:63], a[152:155], v[100:103], v[60:63]
    v_mfma_f32_16x16x32_bf16 v[60:63], a[148:151], v[104:107], v[60:63]
    v_mfma_f32_16x16x32_bf16 v[60:63], a[144:147], v[108:111], v[60:63]
    v_mfma_f32_16x16x32_bf16 v[60:63], a[140:143], v[112:115], v[60:63]
    s_nop 0
    v_mfma_f32_16x16x32_bf16 v[60:63], a[136:139], v[116:119], v[60:63]
    s_nop 0
    v_mfma_f32_16x16x32_bf16 v[60:63], a[132:135], v[120:123], v[60:63]
    ds_write_b128 v21, v[56:59] offset:6144
    v_mfma_f32_16x16x32_bf16 v[60:63], a[128:131], v[124:127], v[60:63]
    v_mfma_f32_16x16x32_bf16 v[60:63], a[188:191], v[128:131], v[60:63]
    v_mfma_f32_16x16x32_bf16 v[60:63], a[184:187], v[132:135], v[60:63]
    v_mfma_f32_16x16x32_bf16 v[60:63], a[180:183], v[136:139], v[60:63]
    v_mfma_f32_16x16x32_bf16 v[60:63], a[176:179], v[140:143], v[60:63]
    v_mfma_f32_16x16x32_bf16 v[60:63], a[172:175], v[144:147], v[60:63]
    v_mfma_f32_16x16x32_bf16 v[60:63], a[168:171], v[148:151], v[60:63]
    v_mfma_f32_16x16x32_bf16 v[60:63], a[164:167], v[152:155], v[60:63]
    v_mfma_f32_16x16x32_bf16 v[60:63], a[160:163], v[156:159], v[60:63]
    v_mfma_f32_16x16x32_bf16 v[60:63], a[220:223], v[160:163], v[60:63]
    v_mfma_f32_16x16x32_bf16 v[60:63], a[216:219], v[164:167], v[60:63]
    v_mfma_f32_16x16x32_bf16 v[60:63], a[212:215], v[168:171], v[60:63]
    v_mfma_f32_16x16x32_bf16 v[60:63], a[208:211], v[172:175], v[60:63]
    v_mfma_f32_16x16x32_bf16 v[60:63], a[204:207], v[176:179], v[60:63]
    v_mfma_f32_16x16x32_bf16 v[60:63], a[200:203], v[180:183], v[60:63]
    v_mfma_f32_16x16x32_bf16 v[60:63], a[196:199], v[184:187], v[60:63]
    v_mfma_f32_16x16x32_bf16 v[60:63], a[192:195], v[188:191], v[60:63]
    s_nop 7
    ds_write_b128 v21, v[60:63] offset:7168
    s_waitcnt vmcnt(3)
    s_waitcnt lgkmcnt(0)
    s_barrier
    ds_read_b128 v[32:35], v22 offset:4096
    ds_read_b128 v[40:43], v22 offset:12288
    ds_read_b128 v[36:39], v26 offset:4096
    ds_read_b128 v[44:47], v26 offset:12288
    s_add_u32 m0, s82, 0x0
    s_add_u32 s42, s42, 57344
    buffer_load_dwordx4 v252, s[12:15], s42 offen offset:0 lds
    buffer_load_dwordx4 v255, s[12:15], s42 offen offset:1024 lds
    s_add_u32 m0, s82, 0x2000
    s_add_u32 s42, s42, 57344
    buffer_load_dwordx4 v252, s[12:15], s42 offen offset:0 lds
    buffer_load_dwordx4 v255, s[12:15], s42 offen offset:1024 lds
    s_add_u32 m0, s82, 0x4000
    s_add_u32 s42, s42, 57344
    buffer_load_dwordx4 v252, s[12:15], s42 offen offset:0 lds
    buffer_load_dwordx4 v255, s[12:15], s42 offen offset:1024 lds
    s_add_u32 m0, s82, 0x6000
    s_add_u32 s42, s42, 57344
    buffer_load_dwordx4 v252, s[12:15], s42 offen offset:0 lds
    buffer_load_dwordx4 v255, s[12:15], s42 offen offset:1024 lds
    s_waitcnt lgkmcnt(2)
    v_pk_add_f32 v[32:33], v[32:33], v[40:41]
    v_pk_add_f32 v[34:35], v[34:35], v[42:43]
    v_pk_fma_f32 v[32:33], v[224:225], v[30:31], v[32:33]
    v_pk_fma_f32 v[34:35], v[226:227], v[30:31], v[34:35]
    v_pk_fma_f32 v[32:33], v[208:209], v[32:33], v[240:241]
    v_pk_fma_f32 v[34:35], v[210:211], v[34:35], v[242:243]
    v_cvt_pk_bf16_f32 v140, v32, v33
    v_cvt_pk_bf16_f32 v141, v34, v35
    v_pk_mul_f32 v[32:33], v[32:33], v[250:251]
    v_pk_mul_f32 v[34:35], v[34:35], v[250:251]
    v_cvt_pk_bf16_f32 v136, v32, v33
    v_cvt_pk_bf16_f32 v137, v34, v35
    s_waitcnt lgkmcnt(0)
    v_pk_add_f32 v[36:37], v[36:37], v[44:45]
    v_pk_add_f32 v[38:39], v[38:39], v[46:47]
    v_pk_fma_f32 v[36:37], v[228:229], v[30:31], v[36:37]
    v_pk_fma_f32 v[38:39], v[230:231], v[30:31], v[38:39]
    v_pk_fma_f32 v[36:37], v[212:213], v[36:37], v[244:245]
    v_pk_fma_f32 v[38:39], v[214:215], v[38:39], v[246:247]
    v_cvt_pk_bf16_f32 v142, v36, v37
    v_cvt_pk_bf16_f32 v143, v38, v39
    v_pk_mul_f32 v[36:37], v[36:37], v[250:251]
    v_pk_mul_f32 v[38:39], v[38:39], v[250:251]
    v_cvt_pk_bf16_f32 v138, v36, v37
    v_cvt_pk_bf16_f32 v139, v38, v39
    buffer_store_dwordx4 v[136:139], v24, s[8:11], s40 offen sc1
    buffer_store_dwordx4 v[140:143], v24, s[8:11], s41 offen sc1
    s_waitcnt vmcnt(11)
    ds_read_b64_tr_b16 a[224:225], v4 offset:0
    ds_read_b64_tr_b16 a[226:227], v4 offset:1024
    ds_read_b64_tr_b16 a[228:229], v7 offset:0
    ds_read_b64_tr_b16 a[230:231], v7 offset:1024
    s_waitcnt lgkmcnt(0)
    buffer_store_dwordx4 a[224:227], v3, s[68:71], s66 offen offset:0 sc1
    buffer_store_dwordx4 a[228:231], v3, s[68:71], s66 offen offset:1024 sc1
    v_mov_b32 v128, 1
    v_lshlrev_b32 v129, 26, v2
    ds_read_b64_tr_b16 a[128:129], v253 offset:32768
    ds_read_b64_tr_b16 a[130:131], v253 offset:33792
    ds_read_b64_tr_b16 a[132:133], v254 offset:32768
    ds_read_b64_tr_b16 a[134:135], v254 offset:33792
    ds_read_b64_tr_b16 a[136:137], v253 offset:40960
    ds_read_b64_tr_b16 a[138:139], v253 offset:41984
    ds_read_b64_tr_b16 a[140:141], v254 offset:40960
    ds_read_b64_tr_b16 a[142:143], v254 offset:41984
    ds_read_b64_tr_b16 a[144:145], v253 offset:49152
    ds_read_b64_tr_b16 a[146:147], v253 offset:50176
    ds_read_b64_tr_b16 a[148:149], v254 offset:49152
    ds_read_b64_tr_b16 a[150:151], v254 offset:50176
    ds_read_b64_tr_b16 a[152:153], v253 offset:57344
    ds_read_b64_tr_b16 a[154:155], v253 offset:58368
    ds_read_b64_tr_b16 a[156:157], v254 offset:57344
    ds_read_b64_tr_b16 a[158:159], v254 offset:58368
    v_add_u32 v253, 0x10000, v253
    v_add_u32 v254, 0x10000, v254
    ds_read_b64_tr_b16 a[160:161], v253 offset:0
    ds_read_b64_tr_b16 a[162:163], v253 offset:1024
    ds_read_b64_tr_b16 a[164:165], v254 offset:0
    ds_read_b64_tr_b16 a[166:167], v254 offset:1024
    ds_read_b64_tr_b16 a[168:169], v253 offset:8192
    ds_read_b64_tr_b16 a[170:171], v253 offset:9216
    ds_read_b64_tr_b16 a[172:173], v254 offset:8192
    ds_read_b64_tr_b16 a[174:175], v254 offset:9216
    ds_read_b64_tr_b16 a[176:177], v253 offset:16384
    ds_read_b64_tr_b16 a[178:179], v253 offset:17408
    ds_read_b64_tr_b16 a[180:181], v254 offset:16384
    ds_read_b64_tr_b16 a[182:183], v254 offset:17408
    v_add_u32 v253, 0xfffe0000, v253
    v_add_u32 v254, 0xfffe0000, v254
    ds_read_b64_tr_b16 a[184:185], v253 offset:9216
    ds_read_b64_tr_b16 a[186:187], v253 offset:10240
    ds_read_b64_tr_b16 a[188:189], v254 offset:9216
    ds_read_b64_tr_b16 a[190:191], v254 offset:10240
    v_add_u32 v253, 0x10000, v253
    v_add_u32 v254, 0x10000, v254
    s_add_u32 s30, s30, 393216
    v_lshrrev_b32 v4, 5, v2
    v_bfe_u32 v5, v2, 2, 2
    v_and_b32 v6, 3, v2
    v_lshlrev_b32 v6, 3, v6
    v_lshl_add_u32 v6, v5, 6, v6
    v_bfe_u32 v5, v2, 4, 1
    v_lshl_add_u32 v6, v5, 5, v6
    v_lshl_add_u32 v12, v4, 9, v6
    v_and_b32 v1, 31, v2
    v_and_b32 v131, 32, v2
    v_lshlrev_b32 v131, 25, v131
    v_lshl_add_u32 v131, v2, 2, v131
    s_mul_i32 s3, s23, 14
    s_mul_i32 s21, s6, 112
    s_add_u32 s3, s3, s21
    s_lshl_b32 s3, s3, 7
    s_add_u32 s3, s3, 7208960
    v_and_b32 v124, 15, v2
    v_min_u32 v124, 13, v124
    v_mul_u32_u24 v123, 56, v5
    v_add_u32 v124, v124, v123
    v_lshl_add_u32 v124, v124, 7, s3
    s_and_b32 s3, s27, 12
    s_add_u32 s3, s3, s23
    s_mul_i32 s3, s3, 7168
    s_add_u32 s3, s3, 6684672
    v_min_u32 v127, 55, v2
    v_lshl_add_u32 v127, v127, 7, s3
    v_add_u32 v126, 393216, v127
    v_mov_b32 v8, v12
    v_add_u32 v9, 57344, v12
    v_lshlrev_b32 v7, 4, v1
    v_lshlrev_b32 v5, 3, v1
    v_lshl_add_u32 v5, v4, 30, v5
    s_lshl2_add_u32 s3, s28, s23
    s_mul_i32 s48, s3, 7
    s_add_u32 s49, s48, s6
    s_xor_b32 s3, s3, 4
    s_mul_i32 s47, s3, 7
    s_lshl1_add_u32 s31, s27, s28
    s_lshl_b32 s0, s23, 10
    s_mul_i32 s1, s23, 7168
    s_xor_b32 s21, s31, 0
    s_mul_i32 s22, s21, 28672
    s_add_u32 s3, s22, s0
    s_add_u32 s50, s3, 25165824
    s_xor_b32 s21, s31, 1
    s_mul_i32 s22, s21, 28672
    s_add_u32 s3, s22, s1
    s_add_u32 s51, s3, 25165824
    s_xor_b32 s21, s31, 0
    s_mul_i32 s22, s21, 28672
    s_lshl_b32 s3, s6, 12
    s_add_u32 s3, s3, s22
    s_add_u32 s3, s3, s0
    s_add_u32 s32, s3, 4194304
    s_lshl_b32 s3, s6, 7
    s_add_u32 s3, s3, s22
    s_add_u32 s44, s3, s1
    s_lshl_b32 s3, s21, 8
    s_add_u32 s64, s3, 6422528
    s_mul_i32 s22, s21, 56
    s_add_u32 s3, s22, s49
    s_lshl_b32 s3, s3, 11
    s_add_u32 s36, s3, 8388608
    s_add_u32 s3, s22, s48
    s_lshl_b32 s3, s3, 11
    s_add_u32 s60, s3, 8388608
    s_add_u32 s3, s22, s47
    s_lshl_b32 s3, s3, 11
    s_add_u32 s61, s3, 8388608
    s_xor_b32 s21, s31, 1
    s_mul_i32 s22, s21, 28672
    s_lshl_b32 s3, s21, 8
    s_add_u32 s65, s3, 6422528
    s_mul_i32 s22, s21, 56
    s_add_u32 s3, s22, s49
    s_lshl_b32 s3, s3, 11
    s_add_u32 s37, s3, 8388608
    s_xor_b32 s21, s31, 32
    s_mul_i32 s22, s21, 28672
    s_add_u32 s3, s22, s1
    s_add_u32 s52, s3, 25165824
    s_lshl_b32 s3, s6, 12
    s_add_u32 s3, s3, s22
    s_add_u32 s3, s3, s0
    s_add_u32 s33, s3, 4194304
    s_lshl_b32 s3, s6, 7
    s_add_u32 s3, s3, s22
    s_add_u32 s45, s3, s1
    s_lshl_b32 s3, s21, 8
    s_add_u32 s66, s3, 6422528
    s_mul_i32 s22, s21, 56
    s_add_u32 s3, s22, s49
    s_lshl_b32 s3, s3, 11
    s_add_u32 s38, s3, 8388608
    s_add_u32 s3, s22, s48
    s_lshl_b32 s3, s3, 11
    s_add_u32 s62, s3, 8388608
    s_add_u32 s3, s22, s47
    s_lshl_b32 s3, s3, 11
    s_add_u32 s63, s3, 8388608
    s_xor_b32 s21, s31, 33
    s_mul_i32 s22, s21, 28672
    s_add_u32 s3, s22, s1
    s_add_u32 s53, s3, 25165824
    s_lshl_b32 s3, s21, 8
    s_add_u32 s67, s3, 6422528
    s_mul_i32 s22, s21, 56
    s_add_u32 s3, s22, s49
    s_lshl_b32 s3, s3, 11
    s_add_u32 s39, s3, 8388608
    s_lshl_b32 s3, s49, 10
    s_add_u32 s54, s3, 6488064
    s_xor_b32 s56, s55, 0x880
    s_xor_b32 s57, s55, 0x100
    s_xor_b32 s7, s55, 0x980
    s_mul_i32 s21, s6, 229376
    s_add_u32 s21, s21, 20971520
    s_lshl_b32 s58, s48, 12
    s_add_u32 s58, s58, s21
    s_lshl_b32 s59, s47, 12
    s_add_u32 s59, s59, s21
    s_lshl_b32 s3, s6, 9
    s_add_u32 s46, s3, 6324224
    v_lshrrev_b32 v4, 3, v2
    v_and_b32 v6, 7, v2
    v_mul_u32_u24 v1, 896, v4
    v_lshl_add_u32 v1, v6, 4, v1
    v_lshlrev_b32 v6, 6, v6
    v_and_b32 v4, 0xf8, v0
    buffer_load_dword v12, v127, s[8:11], 0 offen sc1
    s_waitcnt vmcnt(1)
    v_mov_b32 v13, s5
    buffer_store_dword v13, v131, s[8:11], s30 offen sc1
    buffer_store_dword v13, v131, s[68:71], s81 offen sc1
    s_waitcnt vmcnt(2)
    v_cmp_ne_u32 vcc, s5, v12
    s_nop 4
    s_cbranch_vccz k_h2_go
    s_mov_b32 s22, 400000
k_h2_spin:
    buffer_load_dword v12, v127, s[8:11], 0 offen sc1
    s_waitcnt vmcnt(0)
    v_cmp_ne_u32 vcc, s5, v12
    s_nop 4
    s_cbranch_vccz k_h2_go
    s_sub_u32 s22, s22, 1
    s_cmp_lg_u32 s22, 0
    s_cbranch_scc1 k_h2_spin
k_h2_go:
    s_waitcnt lgkmcnt(0)
    s_barrier
    s_add_u32 m0, s0, 0
    s_nop 0
    buffer_load_dwordx4 v3, s[8:11], s50 offen offset:0 sc1 lds
    s_add_u32 m0, s0, 4096
    s_add_u32 s50, s50, 4096
    buffer_load_dwordx4 v3, s[8:11], s50 offen offset:0 sc1 lds
    s_add_u32 m0, s0, 8192
    s_add_u32 s50, s50, 4096
    buffer_load_dwordx4 v3, s[8:11], s50 offen offset:0 sc1 lds
    s_add_u32 m0, s0, 12288
    s_add_u32 s50, s50, 4096
    buffer_load_dwordx4 v3, s[8:11], s50 offen offset:0 sc1 lds
    s_add_u32 m0, s0, 16384
    s_add_u32 s50, s50, 4096
    buffer_load_dwordx4 v3, s[8:11], s50 offen offset:0 sc1 lds
    s_add_u32 m0, s0, 20480
    s_add_u32 s50, s50, 4096
    buffer_load_dwordx4 v3, s[8:11], s50 offen offset:0 sc1 lds
    s_add_u32 m0, s0, 24576
    s_add_u32 s50, s50, 4096
    buffer_load_dwordx4 v3, s[8:11], s50 offen offset:0 sc1 lds
    s_add_u32 m0, s1, 28672
    s_nop 0
    buffer_load_dwordx4 v3, s[8:11], s51 offen offset:0 sc1 lds
    buffer_load_dwordx4 v3, s[8:11], s51 offen offset:1024 sc1 lds
    buffer_load_dwordx4 v3, s[8:11], s51 offen offset:2048 sc1 lds
    buffer_load_dwordx4 v3, s[8:11], s51 offen offset:3072 sc1 lds
    ds_read_b64_tr_b16 a[192:193], v253 offset:0
    ds_read_b64_tr_b16 a[194:195], v253 offset:1024
    ds_read_b64_tr_b16 a[196:197], v254 offset:0
    ds_read_b64_tr_b16 a[198:199], v254 offset:1024
    ds_read_b64_tr_b16 a[200:201], v253 offset:8192
    ds_read_b64_tr_b16 a[202:203], v253 offset:9216
    ds_read_b64_tr_b16 a[204:205], v254 offset:8192
    ds_read_b64_tr_b16 a[206:207], v254 offset:9216
    ds_read_b64_tr_b16 a[208:209], v253 offset:16384
    ds_read_b64_tr_b16 a[210:211], v253 offset:17408
    ds_read_b64_tr_b16 a[212:213], v254 offset:16384
    ds_read_b64_tr_b16 a[214:215], v254 offset:17408
    ds_read_b64_tr_b16 a[216:217], v253 offset:24576
    ds_read_b64_tr_b16 a[218:219], v253 offset:25600
    ds_read_b64_tr_b16 a[220:221], v254 offset:24576
    ds_read_b64_tr_b16 a[222:223], v254 offset:25600
    s_waitcnt lgkmcnt(0)
    s_waitcnt vmcnt(9)
    s_barrier
    ds_read_b64_tr_b16 v[80:81], v8 offset:0
    ds_read_b64_tr_b16 v[82:83], v8 offset:256
    ds_read_b64_tr_b16 v[84:85], v8 offset:1024
    ds_read_b64_tr_b16 v[86:87], v8 offset:1280
    ds_read_b64_tr_b16 v[88:89], v8 offset:2048
    ds_read_b64_tr_b16 v[90:91], v8 offset:2304
    ds_read_b64_tr_b16 v[92:93], v8 offset:3072
    ds_read_b64_tr_b16 v[94:95], v8 offset:3328
    s_waitcnt lgkmcnt(6)
    v_mfma_f32_32x32x16_bf16 v[16:31], a[0:3], v[80:83], 0
    ds_read_b64_tr_b16 v[96:97], v8 offset:4096
    ds_read_b64_tr_b16 v[98:99], v8 offset:4352
    v_mfma_f32_32x32x16_bf16 v[32:47], a[4:7], v[80:83], 0
    s_waitcnt lgkmcnt(6)
    v_mfma_f32_32x32x16_bf16 v[16:31], a[8:11], v[84:87], v[16:31]
    ds_read_b64_tr_b16 v[100:101], v8 offset:5120
    ds_read_b64_tr_b16 v[102:103], v8 offset:5376
    v_mfma_f32_32x32x16_bf16 v[32:47], a[12:15], v[84:87], v[32:47]
    s_add_u32 m0, s1, 32768
    s_add_u32 s51, s51, 4096
    buffer_load_dwordx4 v3, s[8:11], s51 offen offset:0 sc1 lds
    s_waitcnt lgkmcnt(6)
    v_mfma_f32_32x32x16_bf16 v[16:31], a[16:19], v[88:91], v[16:31]
    ds_read_b64_tr_b16 v[80:81], v8 offset:6144
    ds_read_b64_tr_b16 v[82:83], v8 offset:6400
    v_mfma_f32_32x32x16_bf16 v[32:47], a[20:23], v[88:91], v[32:47]
    buffer_load_dwordx4 v3, s[8:11], s51 offen offset:1024 sc1 lds
    s_waitcnt lgkmcnt(6)
    v_mfma_f32_32x32x16_bf16 v[16:31], a[24:27], v[92:95], v[16:31]
    ds_read_b64_tr_b16 v[84:85], v8 offset:7168
    ds_read_b64_tr_b16 v[86:87], v8 offset:7424
    v_mfma_f32_32x32x16_bf16 v[32:47], a[28:31], v[92:95], v[32:47]
    buffer_load_dwordx4 v3, s[8:11], s51 offen offset:2048 sc1 lds
    s_waitcnt lgkmcnt(6)
    v_mfma_f32_32x32x16_bf16 v[16:31], a[32:35], v[96:99], v[16:31]
    s_waitcnt vmcnt(10)
    s_barrier
    ds_read_b64_tr_b16 v[88:89], v8 offset:8192
    ds_read_b64_tr_b16 v[90:91], v8 offset:8448
    v_mfma_f32_32x32x16_bf16 v[32:47], a[36:39], v[96:99], v[32:47]
    s_add_u32 m0, s0, 147456
    s_nop 0
    buffer_load_dwordx4 v3, s[8:11], s32 offen sc1 lds
    s_waitcnt lgkmcnt(6)
    v_mfma_f32_32x32x16_bf16 v[16:31], a[40:43], v[100:103], v[16:31]
    ds_read_b64_tr_b16 v[92:93], v8 offset:9216
    ds_read_b64_tr_b16 v[94:95], v8 offset:9472
    buffer_load_dword v123, v124, s[8:11], 0 offen sc1
    v_mfma_f32_32x32x16_bf16 v[32:47], a[44:47], v[100:103], v[32:47]
    s_waitcnt lgkmcnt(6)
    v_mfma_f32_32x32x16_bf16 v[16:31], a[48:51], v[80:83], v[16:31]
    ds_read_b64_tr_b16 v[96:97], v8 offset:10240
    ds_read_b64_tr_b16 v[98:99], v8 offset:10496
    v_mfma_f32_32x32x16_bf16 v[32:47], a[52:55], v[80:83], v[32:47]
    s_waitcnt lgkmcnt(6)
    v_mfma_f32_32x32x16_bf16 v[16:31], a[56:59], v[84:87], v[16:31]
    ds_read_b64_tr_b16 v[100:101], v8 offset:11264
    ds_read_b64_tr_b16 v[102:103], v8 offset:11520
    v_mfma_f32_32x32x16_bf16 v[32:47], a[60:63], v[84:87], v[32:47]
    s_waitcnt lgkmcnt(6)
    v_mfma_f32_32x32x16_bf16 v[16:31], a[64:67], v[88:91], v[16:31]
    ds_read_b64_tr_b16 v[80:81], v8 offset:12288
    ds_read_b64_tr_b16 v[82:83], v8 offset:12544
    v_mfma_f32_32x32x16_bf16 v[32:47], a[68:71], v[88:91], v[32:47]
    s_waitcnt lgkmcnt(6)
    v_mfma_f32_32x32x16_bf16 v[16:31], a[72:75], v[92:95], v[16:31]
    ds_read_b64_tr_b16 v[84:85], v8 offset:13312
    ds_read_b64_tr_b16 v[86:87], v8 offset:13568
    v_mfma_f32_32x32x16_bf16 v[32:47], a[76:79], v[92:95], v[32:47]
    s_waitcnt lgkmcnt(6)
    v_mfma_f32_32x32x16_bf16 v[16:31], a[80:83], v[96:99], v[16:31]
    ds_read_b64_tr_b16 v[88:89], v8 offset:14336
    ds_read_b64_tr_b16 v[90:91], v8 offset:14592
    v_mfma_f32_32x32x16_bf16 v[32:47], a[84:87], v[96:99], v[32:47]
    s_waitcnt lgkmcnt(6)
    v_mfma_f32_32x32x16_bf16 v[16:31], a[88:91], v[100:103], v[16:31]
    ds_read_b64_tr_b16 v[92:93], v8 offset:15360
    ds_read_b64_tr_b16 v[94:95], v8 offset:15616
    v_mfma_f32_32x32x16_bf16 v[32:47], a[92:95], v[100:103], v[32:47]
    s_waitcnt lgkmcnt(6)
    v_mfma_f32_32x32x16_bf16 v[16:31], a[96:99], v[80:83], v[16:31]
    s_waitcnt vmcnt(9)
    s_barrier
    ds_read_b64_tr_b16 v[96:97], v8 offset:16384
    ds_read_b64_tr_b16 v[98:99], v8 offset:16640
    v_mfma_f32_32x32x16_bf16 v[32:47], a[100:103], v[80:83], v[32:47]
    s_waitcnt lgkmcnt(6)
    v_mfma_f32_32x32x16_bf16 v[16:31], a[104:107], v[84:87], v[16:31]
    ds_read_b64_tr_b16 v[100:101], v8 offset:17408
    ds_read_b64_tr_b16 v[102:103], v8 offset:17664
    buffer_load_dword v125, v126, s[8:11], 0 offen sc1
    v_mfma_f32_32x32x16_bf16 v[32:47], a[108:111], v[84:87], v[32:47]
    s_waitcnt lgkmcnt(6)
    v_mfma_f32_32x32x16_bf16 v[16:31], a[112:115], v[88:91], v[16:31]
    ds_read_b64_tr_b16 v[80:81], v8 offset:18432
    ds_read_b64_tr_b16 v[82:83], v8 offset:18688
    v_mfma_f32_32x32x16_bf16 v[32:47], a[116:119], v[88:91], v[32:47]
    s_waitcnt lgkmcnt(6)
    v_mfma_f32_32x32x16_bf16 v[16:31], a[120:123], v[92:95], v[16:31]
    ds_read_b64_tr_b16 v[84:85], v8 offset:19456
    ds_read_b64_tr_b16 v[86:87], v8 offset:19712
    v_mfma_f32_32x32x16_bf16 v[32:47], a[124:127], v[92:95], v[32:47]
    s_waitcnt lgkmcnt(6)
    v_mfma_f32_32x32x16_bf16 v[16:31], a[128:131], v[96:99], v[16:31]
    ds_read_b64_tr_b16 v[88:89], v8 offset:20480
    ds_read_b64_tr_b16 v[90:91], v8 offset:20736
    s_waitcnt vmcnt(1)
    v_cmp_ne_u32 vcc, s5, v123
    s_nop 1
    s_cmp_lg_u64 vcc, 0
    s_cbranch_scc1 k_slow_fe
k_ok_fe:
    v_mfma_f32_32x32x16_bf16 v[32:47], a[132:135], v[96:99], v[32:47]
    buffer_load_dwordx4 v[132:135], v3, s[8:11], s58 offen offset:0 sc1
    s_waitcnt lgkmcnt(6)
    v_mfma_f32_32x32x16_bf16 v[16:31], a[136:139], v[100:103], v[16:31]
    ds_read_b64_tr_b16 v[92:93], v8 offset:21504
    ds_read_b64_tr_b16 v[94:95], v8 offset:21760
    v_mfma_f32_32x32x16_bf16 v[32:47], a[140:143], v[100:103], v[32:47]
    buffer_load_dwordx4 v[136:139], v3, s[8:11], s58 offen offset:1024 sc1
    s_waitcnt lgkmcnt(6)
    v_mfma_f32_32x32x16_bf16 v[16:31], a[144:147], v[80:83], v[16:31]
    ds_read_b64_tr_b16 v[96:97], v8 offset:22528
    ds_read_b64_tr_b16 v[98:99], v8 offset:22784
    v_mfma_f32_32x32x16_bf16 v[32:47], a[148:151], v[80:83], v[32:47]
    buffer_load_dwordx4 v[140:143], v3, s[8:11], s58 offen offset:2048 sc1
    s_waitcnt lgkmcnt(6)
    v_mfma_f32_32x32x16_bf16 v[16:31], a[152:155], v[84:87], v[16:31]
    ds_read_b64_tr_b16 v[100:101], v8 offset:23552
    ds_read_b64_tr_b16 v[102:103], v8 offset:23808
    v_mfma_f32_32x32x16_bf16 v[32:47], a[156:159], v[84:87], v[32:47]
    buffer_load_dwordx4 v[144:147], v3, s[8:11], s58 offen offset:3072 sc1
    s_waitcnt lgkmcnt(6)
    v_mfma_f32_32x32x16_bf16 v[16:31], a[160:163], v[88:91], v[16:31]
    ds_read_b64_tr_b16 v[80:81], v8 offset:24576
    ds_read_b64_tr_b16 v[82:83], v8 offset:24832
    v_mfma_f32_32x32x16_bf16 v[32:47], a[164:167], v[88:91], v[32:47]
    s_add_u32 s58, s58, 4096
    buffer_load_dwordx4 v[148:151], v3, s[8:11], s58 offen offset:0 sc1
    s_waitcnt lgkmcnt(6)
    v_mfma_f32_32x32x16_bf16 v[16:31], a[168:171], v[92:95], v[16:31]
    ds_read_b64_tr_b16 v[84:85], v8 offset:25600
    ds_read_b64_tr_b16 v[86:87], v8 offset:25856
    v_mfma_f32_32x32x16_bf16 v[32:47], a[172:175], v[92:95], v[32:47]
    buffer_load_dwordx4 v[152:155], v3, s[8:11], s58 offen offset:1024 sc1
    s_waitcnt lgkmcnt(6)
    v_mfma_f32_32x32x16_bf16 v[16:31], a[176:179], v[96:99], v[16:31]
    ds_read_b64_tr_b16 v[88:89], v8 offset:26624
    ds_read_b64_tr_b16 v[90:91], v8 offset:26880
    v_mfma_f32_32x32x16_bf16 v[32:47], a[180:183], v[96:99], v[32:47]
    buffer_load_dwordx4 v[156:159], v3, s[8:11], s58 offen offset:2048 sc1
    s_waitcnt lgkmcnt(6)
    v_mfma_f32_32x32x16_bf16 v[16:31], a[184:187], v[100:103], v[16:31]
    ds_read_b64_tr_b16 v[92:93], v8 offset:27648
    ds_read_b64_tr_b16 v[94:95], v8 offset:27904
    v_mfma_f32_32x32x16_bf16 v[32:47], a[188:191], v[100:103], v[32:47]
    buffer_load_dwordx4 v[160:163], v3, s[8:11], s58 offen offset:3072 sc1
    s_waitcnt lgkmcnt(6)
    v_mfma_f32_32x32x16_bf16 v[16:31], a[192:195], v[80:83], v[16:31]
    s_barrier
    ds_read_b64_tr_b16 v[96:97], v8 offset:28672
    ds_read_b64_tr_b16 v[98:99], v8 offset:28928
    s_waitcnt vmcnt(8)
    v_cmp_ne_u32 vcc, s5, v125
    s_nop 1
    s_cmp_lg_u64 vcc, 0
    s_cbranch_scc1 k_slow_fd
k_ok_fd:
    s_barrier
    v_mfma_f32_32x32x16_bf16 v[32:47], a[196:199], v[80:83], v[32:47]
    s_add_u32 m0, s1, 57344
    s_nop 0
    buffer_load_dwordx4 v3, s[8:11], s52 offen offset:0 sc1 lds
    s_waitcnt lgkmcnt(6)
    v_mfma_f32_32x32x16_bf16 v[16:31], a[200:203], v[84:87], v[16:31]
    ds_read_b64_tr_b16 v[100:101], v8 offset:29696
    ds_read_b64_tr_b16 v[102:103], v8 offset:29952
    v_mfma_f32_32x32x16_bf16 v[32:47], a[204:207], v[84:87], v[32:47]
    buffer_load_dwordx4 v3, s[8:11], s52 offen offset:1024 sc1 lds
    s_waitcnt lgkmcnt(6)
    v_mfma_f32_32x32x16_bf16 v[16:31], a[208:211], v[88:91], v[16:31]
    ds_read_b64_tr_b16 v[80:81], v8 offset:30720
    ds_read_b64_tr_b16 v[82:83], v8 offset:30976
    v_mfma_f32_32x32x16_bf16 v[32:47], a[212:215], v[88:91], v[32:47]
    buffer_load_dwordx4 v3, s[8:11], s52 offen offset:2048 sc1 lds
    s_waitcnt lgkmcnt(6)
    v_mfma_f32_32x32x16_bf16 v[16:31], a[216:219], v[92:95], v[16:31]
    ds_read_b64_tr_b16 v[84:85], v8 offset:31744
    ds_read_b64_tr_b16 v[86:87], v8 offset:32000
    v_mfma_f32_32x32x16_bf16 v[32:47], a[220:223], v[92:95], v[32:47]
    buffer_load_dwordx4 v3, s[8:11], s52 offen offset:3072 sc1 lds
    s_waitcnt lgkmcnt(6)
    v_mfma_f32_32x32x16_bf16 v[48:63], a[0:3], v[96:99], 0
    ds_read_b64_tr_b16 v[88:89], v8 offset:32768
    ds_read_b64_tr_b16 v[90:91], v8 offset:33024
    v_mfma_f32_32x32x16_bf16 v[64:79], a[4:7], v[96:99], 0
    s_add_u32 m0, s1, 61440
    s_add_u32 s52, s52, 4096
    buffer_load_dwordx4 v3, s[8:11], s52 offen offset:0 sc1 lds
    s_waitcnt lgkmcnt(6)
    v_mfma_f32_32x32x16_bf16 v[48:63], a[8:11], v[100:103], v[48:63]
    ds_read_b64_tr_b16 v[92:93], v8 offset:33792
    ds_read_b64_tr_b16 v[94:95], v8 offset:34048
    v_mfma_f32_32x32x16_bf16 v[64:79], a[12:15], v[100:103], v[64:79]
    buffer_load_dwordx4 v[112:115], v7, s[8:11], s54 offen offset:0 sc1
    s_waitcnt lgkmcnt(6)
    v_mfma_f32_32x32x16_bf16 v[48:63], a[16:19], v[80:83], v[48:63]
    ds_read_b64_tr_b16 v[96:97], v8 offset:34816
    ds_read_b64_tr_b16 v[98:99], v8 offset:35072
    v_mfma_f32_32x32x16_bf16 v[64:79], a[20:23], v[80:83], v[64:79]
    buffer_load_dwordx4 v[116:119], v7, s[8:11], s54 offen offset:512 sc1
    s_waitcnt lgkmcnt(6)
    v_mfma_f32_32x32x16_bf16 v[48:63], a[24:27], v[84:87], v[48:63]
    ds_read_b64_tr_b16 v[100:101], v8 offset:35840
    ds_read_b64_tr_b16 v[102:103], v8 offset:36096
    v_mfma_f32_32x32x16_bf16 v[64:79], a[28:31], v[84:87], v[64:79]
    buffer_load_dwordx2 v[104:105], v5, s[8:11], s64 offen sc1
    s_waitcnt lgkmcnt(6)
    v_mfma_f32_32x32x16_bf16 v[48:63], a[32:35], v[88:91], v[48:63]
    ds_read_b64_tr_b16 v[80:81], v8 offset:36864
    ds_read_b64_tr_b16 v[82:83], v8 offset:37120
    v_mfma_f32_32x32x16_bf16 v[64:79], a[36:39], v[88:91], v[64:79]
    buffer_load_dwordx2 v[106:107], v5, s[8:11], s65 offen sc1
    s_waitcnt lgkmcnt(6)
    v_mfma_f32_32x32x16_bf16 v[48:63], a[40:43], v[92:95], v[48:63]
    ds_read_b64_tr_b16 v[84:85], v8 offset:37888
    ds_read_b64_tr_b16 v[86:87], v8 offset:38144
    v_mfma_f32_32x32x16_bf16 v[64:79], a[44:47], v[92:95], v[64:79]
    buffer_load_dwordx4 v3, s[8:11], s52 offen offset:1024 sc1 lds
    s_waitcnt lgkmcnt(6)
    v_mfma_f32_32x32x16_bf16 v[48:63], a[48:51], v[96:99], v[48:63]
    ds_read_b64_tr_b16 v[88:89], v8 offset:38912
    ds_read_b64_tr_b16 v[90:91], v8 offset:39168
    v_mfma_f32_32x32x16_bf16 v[64:79], a[52:55], v[96:99], v[64:79]
    buffer_load_dwordx4 v3, s[8:11], s52 offen offset:2048 sc1 lds
    s_waitcnt lgkmcnt(6)
    v_mfma_f32_32x32x16_bf16 v[48:63], a[56:59], v[100:103], v[48:63]
    ds_read_b64_tr_b16 v[92:93], v8 offset:39936
    ds_read_b64_tr_b16 v[94:95], v8 offset:40192
    v_mfma_f32_32x32x16_bf16 v[64:79], a[60:63], v[100:103], v[64:79]
    s_add_u32 m0, s1, 86016
    s_nop 0
    buffer_load_dwordx4 v3, s[8:11], s53 offen offset:0 sc1 lds
    s_waitcnt lgkmcnt(6)
    v_mfma_f32_32x32x16_bf16 v[48:63], a[64:67], v[80:83], v[48:63]
    ds_read_b64_tr_b16 v[96:97], v8 offset:40960
    ds_read_b64_tr_b16 v[98:99], v8 offset:41216
    v_mfma_f32_32x32x16_bf16 v[64:79], a[68:71], v[80:83], v[64:79]
    buffer_load_dwordx4 v3, s[8:11], s53 offen offset:1024 sc1 lds
    s_waitcnt lgkmcnt(6)
    v_mfma_f32_32x32x16_bf16 v[48:63], a[72:75], v[84:87], v[48:63]
    ds_read_b64_tr_b16 v[100:101], v8 offset:41984
    ds_read_b64_tr_b16 v[102:103], v8 offset:42240
    v_mfma_f32_32x32x16_bf16 v[64:79], a[76:79], v[84:87], v[64:79]
    buffer_load_dwordx4 v3, s[8:11], s53 offen offset:2048 sc1 lds
    s_waitcnt lgkmcnt(6)
    v_mfma_f32_32x32x16_bf16 v[48:63], a[80:83], v[88:91], v[48:63]
    ds_read_b64_tr_b16 v[80:81], v8 offset:43008
    ds_read_b64_tr_b16 v[82:83], v8 offset:43264
    v_mfma_f32_32x32x16_bf16 v[64:79], a[84:87], v[88:91], v[64:79]
    buffer_load_dwordx4 v3, s[8:11], s53 offen offset:3072 sc1 lds
    s_waitcnt lgkmcnt(6)
    v_mfma_f32_32x32x16_bf16 v[48:63], a[88:91], v[92:95], v[48:63]
    ds_read_b64_tr_b16 v[84:85], v8 offset:44032
    ds_read_b64_tr_b16 v[86:87], v8 offset:44288
    v_mfma_f32_32x32x16_bf16 v[64:79], a[92:95], v[92:95], v[64:79]
    s_add_u32 m0, s1, 90112
    s_add_u32 s53, s53, 4096
    buffer_load_dwordx4 v3, s[8:11], s53 offen offset:0 sc1 lds
    s_waitcnt lgkmcnt(6)
    v_mfma_f32_32x32x16_bf16 v[48:63], a[96:99], v[96:99], v[48:63]
    ds_read_b64_tr_b16 v[88:89], v8 offset:45056
    ds_read_b64_tr_b16 v[90:91], v8 offset:45312
    v_mfma_f32_32x32x16_bf16 v[64:79], a[100:103], v[96:99], v[64:79]
    buffer_load_dwordx4 v3, s[8:11], s53 offen offset:1024 sc1 lds
    s_waitcnt lgkmcnt(6)
    v_mfma_f32_32x32x16_bf16 v[48:63], a[104:107], v[100:103], v[48:63]
    ds_read_b64_tr_b16 v[92:93], v8 offset:46080
    ds_read_b64_tr_b16 v[94:95], v8 offset:46336
    v_mfma_f32_32x32x16_bf16 v[64:79], a[108:111], v[100:103], v[64:79]
    buffer_load_dwordx4 v3, s[8:11], s53 offen offset:2048 sc1 lds
    s_waitcnt lgkmcnt(6)
    v_mfma_f32_32x32x16_bf16 v[48:63], a[112:115], v[80:83], v[48:63]
    ds_read_b64_tr_b16 v[96:97], v8 offset:47104
    ds_read_b64_tr_b16 v[98:99], v8 offset:47360
    v_mfma_f32_32x32x16_bf16 v[64:79], a[116:119], v[80:83], v[64:79]
    s_add_u32 m0, s0, 151552
    s_nop 0
    buffer_load_dwordx4 v3, s[8:11], s33 offen sc1 lds
    s_waitcnt lgkmcnt(6)
    v_mfma_f32_32x32x16_bf16 v[48:63], a[120:123], v[84:87], v[48:63]
    ds_read_b64_tr_b16 v[100:101], v8 offset:48128
    ds_read_b64_tr_b16 v[102:103], v8 offset:48384
    s_waitcnt vmcnt(10)
    v_min_u32 v130, v105, v107
    v_cmp_ne_u32 s[76:77], s5, v114
    v_cmp_ne_u32 s[78:79], s5, v118
    v_cmp_eq_u32 vcc, 0, v130
    s_or_b32 s76, s76, s78
    s_nop 0
    s_or_b32 s3, s76, vcc_lo
    s_cbranch_scc1 k_slow_rk
k_ok_rk:
    v_mfma_f32_32x32x8_bf16 v[16:31], v[112:113], v[104:105], v[16:31]
    v_mfma_f32_32x32x8_bf16 v[32:47], v[116:117], v[104:105], v[32:47]
    v_mfma_f32_32x32x16_bf16 v[64:79], a[124:127], v[84:87], v[64:79]
    s_add_u32 s58, s58, 4096
    buffer_load_dwordx4 v[164:167], v3, s[8:11], s58 offen offset:0 sc1
    s_waitcnt lgkmcnt(6)
    v_mfma_f32_32x32x16_bf16 v[48:63], a[128:131], v[88:91], v[48:63]
    ds_read_b64_tr_b16 v[80:81], v8 offset:49152
    ds_read_b64_tr_b16 v[82:83], v8 offset:49408
    v_mfma_f32_32x32x16_bf16 v[64:79], a[132:135], v[88:91], v[64:79]
    buffer_load_dwordx4 v[168:171], v3, s[8:11], s58 offen offset:1024 sc1
    s_waitcnt lgkmcnt(6)
    v_mfma_f32_32x32x16_bf16 v[48:63], a[136:139], v[92:95], v[48:63]
    ds_read_b64_tr_b16 v[84:85], v8 offset:50176
    ds_read_b64_tr_b16 v[86:87], v8 offset:50432
    v_max_f32 v16, 0, v16
    v_max_f32 v17, 0, v17
    v_max_f32 v18, 0, v18
    v_max_f32 v19, 0, v19
    v_mfma_f32_32x32x16_bf16 v[64:79], a[140:143], v[92:95], v[64:79]
    buffer_load_dwordx4 v[172:175], v3, s[8:11], s58 offen offset:2048 sc1
    s_waitcnt lgkmcnt(6)
    v_mfma_f32_32x32x16_bf16 v[48:63], a[144:147], v[96:99], v[48:63]
    ds_read_b64_tr_b16 v[88:89], v8 offset:51200
    ds_read_b64_tr_b16 v[90:91], v8 offset:51456
    v_max_f32 v20, 0, v20
    v_max_f32 v21, 0, v21
    v_max_f32 v22, 0, v22
    v_max_f32 v23, 0, v23
    v_mfma_f32_32x32x16_bf16 v[64:79], a[148:151], v[96:99], v[64:79]
    buffer_load_dwordx4 v[176:179], v3, s[8:11], s58 offen offset:3072 sc1
    s_waitcnt lgkmcnt(6)
    v_mfma_f32_32x32x16_bf16 v[48:63], a[152:155], v[100:103], v[48:63]
    ds_read_b64_tr_b16 v[92:93], v8 offset:52224
    ds_read_b64_tr_b16 v[94:95], v8 offset:52480
    v_mul_f32 v16, v16, v24
    v_mul_f32 v17, v17, v25
    v_mul_f32 v18, v18, v26
    v_mul_f32 v19, v19, v27
    v_mfma_f32_32x32x16_bf16 v[64:79], a[156:159], v[100:103], v[64:79]
    s_add_u32 s58, s58, 4096
    buffer_load_dwordx4 v[180:183], v3, s[8:11], s58 offen offset:0 sc1
    s_waitcnt lgkmcnt(6)
    v_mfma_f32_32x32x16_bf16 v[48:63], a[160:163], v[80:83], v[48:63]
    ds_read_b64_tr_b16 v[96:97], v8 offset:53248
    ds_read_b64_tr_b16 v[98:99], v8 offset:53504
    v_mul_f32 v20, v20, v28
    v_mul_f32 v21, v21, v29
    v_mul_f32 v22, v22, v30
    v_mul_f32 v23, v23, v31
    v_mfma_f32_32x32x16_bf16 v[64:79], a[164:167], v[80:83], v[64:79]
    v_cvt_pk_bf16_f32 v120, v16, v17
    v_cvt_pk_bf16_f32 v121, v18, v19
    v_cvt_pk_bf16_f32 v122, v20, v21
    v_cvt_pk_bf16_f32 v123, v22, v23
    s_waitcnt lgkmcnt(6)
    v_mfma_f32_32x32x16_bf16 v[48:63], a[168:171], v[84:87], v[48:63]
    ds_read_b64_tr_b16 v[100:101], v8 offset:54272
    ds_read_b64_tr_b16 v[102:103], v8 offset:54528
    v_max_f32 v32, 0, v32
    v_max_f32 v33, 0, v33
    v_max_f32 v34, 0, v34
    v_max_f32 v35, 0, v35
    v_mfma_f32_32x32x16_bf16 v[64:79], a[172:175], v[84:87], v[64:79]
    buffer_store_dwordx4 v[120:123], v3, s[8:11], s36 offen offset:0 sc1
    s_waitcnt lgkmcnt(6)
    v_mfma_f32_32x32x16_bf16 v[48:63], a[176:179], v[88:91], v[48:63]
    ds_read_b64_tr_b16 v[80:81], v8 offset:55296
    ds_read_b64_tr_b16 v[82:83], v8 offset:55552
    v_max_f32 v36, 0, v36
    v_max_f32 v37, 0, v37
    v_max_f32 v38, 0, v38
    v_max_f32 v39, 0, v39
    v_mfma_f32_32x32x16_bf16 v[64:79], a[180:183], v[88:91], v[64:79]
    buffer_load_dwordx4 v[184:187], v3, s[8:11], s58 offen offset:1024 sc1
    s_waitcnt lgkmcnt(6)
    v_mfma_f32_32x32x16_bf16 v[48:63], a[184:187], v[92:95], v[48:63]
    ds_read_b64_tr_b16 v[84:85], v8 offset:56320
    ds_read_b64_tr_b16 v[86:87], v8 offset:56576
    v_mul_f32 v32, v32, v40
    v_mul_f32 v33, v33, v41
    v_mul_f32 v34, v34, v42
    v_mul_f32 v35, v35, v43
    v_mfma_f32_32x32x16_bf16 v[64:79], a[188:191], v[92:95], v[64:79]
    buffer_load_dwordx4 v[188:191], v3, s[8:11], s58 offen offset:2048 sc1
    s_waitcnt lgkmcnt(6)
    v_mfma_f32_32x32x16_bf16 v[48:63], a[192:195], v[96:99], v[48:63]
    s_waitcnt vmcnt(16)
    s_barrier
    ds_read_b64_tr_b16 v[88:89], v9 offset:0
    ds_read_b64_tr_b16 v[90:91], v9 offset:256
    v_mul_f32 v36, v36, v44
    v_mul_f32 v37, v37, v45
    v_mul_f32 v38, v38, v46
    v_mul_f32 v39, v39, v47
    v_mfma_f32_32x32x16_bf16 v[64:79], a[196:199], v[96:99], v[64:79]
    buffer_load_dwordx4 v[192:195], v3, s[8:11], s58 offen offset:3072 sc1
    s_waitcnt lgkmcnt(6)
    v_mfma_f32_32x32x16_bf16 v[48:63], a[200:203], v[100:103], v[48:63]
    ds_read_b64_tr_b16 v[92:93], v9 offset:1024
    ds_read_b64_tr_b16 v[94:95], v9 offset:1280
    v_cvt_pk_bf16_f32 v124, v32, v33
    v_cvt_pk_bf16_f32 v125, v34, v35
    v_cvt_pk_bf16_f32 v126, v36, v37
    v_cvt_pk_bf16_f32 v127, v38, v39
    v_mfma_f32_32x32x16_bf16 v[64:79], a[204:207], v[100:103], v[64:79]
    buffer_store_dwordx4 v[124:127], v3, s[8:11], s36 offen offset:1024 sc1
    s_waitcnt lgkmcnt(6)
    v_mfma_f32_32x32x16_bf16 v[48:63], a[208:211], v[80:83], v[48:63]
    ds_read_b64_tr_b16 v[96:97], v9 offset:2048
    ds_read_b64_tr_b16 v[98:99], v9 offset:2304
    v_mfma_f32_32x32x16_bf16 v[64:79], a[212:215], v[80:83], v[64:79]
    s_add_u32 s58, s58, 4096
    buffer_load_dwordx4 v[196:199], v3, s[8:11], s58 offen offset:0 sc1
    s_waitcnt lgkmcnt(6)
    v_mfma_f32_32x32x16_bf16 v[48:63], a[216:219], v[84:87], v[48:63]
    ds_read_b64_tr_b16 v[100:101], v9 offset:3072
    ds_read_b64_tr_b16 v[102:103], v9 offset:3328
    v_mfma_f32_32x32x16_bf16 v[64:79], a[220:223], v[84:87], v[64:79]
    v_mfma_f32_32x32x8_bf16 v[48:63], v[112:113], v[106:107], v[48:63]
    v_mfma_f32_32x32x8_bf16 v[64:79], v[116:117], v[106:107], v[64:79]
    buffer_load_dwordx4 v[200:203], v3, s[8:11], s58 offen offset:1024 sc1
    s_waitcnt lgkmcnt(6)
    v_mfma_f32_32x32x16_bf16 v[16:31], a[0:3], v[88:91], 0
    ds_read_b64_tr_b16 v[80:81], v9 offset:4096
    ds_read_b64_tr_b16 v[82:83], v9 offset:4352
    v_mfma_f32_32x32x16_bf16 v[32:47], a[4:7], v[88:91], 0
    buffer_load_dwordx4 v[204:207], v3, s[8:11], s58 offen offset:2048 sc1
    s_waitcnt lgkmcnt(6)
    v_mfma_f32_32x32x16_bf16 v[16:31], a[8:11], v[92:95], v[16:31]
    ds_read_b64_tr_b16 v[84:85], v9 offset:5120
    ds_read_b64_tr_b16 v[86:87], v9 offset:5376
    v_mfma_f32_32x32x16_bf16 v[32:47], a[12:15], v[92:95], v[32:47]
    buffer_load_dwordx4 v[208:211], v3, s[8:11], s58 offen offset:3072 sc1
    s_waitcnt lgkmcnt(6)
    v_mfma_f32_32x32x16_bf16 v[16:31], a[16:19], v[96:99], v[16:31]
    ds_read_b64_tr_b16 v[88:89], v9 offset:6144
    ds_read_b64_tr_b16 v[90:91], v9 offset:6400
    v_max_f32 v48, 0, v48
    v_max_f32 v49, 0, v49
    v_max_f32 v50, 0, v50
    v_max_f32 v51, 0, v51
    v_mfma_f32_32x32x16_bf16 v[32:47], a[20:23], v[96:99], v[32:47]
    s_add_u32 s58, s58, 4096
    buffer_load_dwordx4 v[212:215], v3, s[8:11], s58 offen offset:0 sc1
    s_waitcnt lgkmcnt(6)
    v_mfma_f32_32x32x16_bf16 v[16:31], a[24:27], v[100:103], v[16:31]
    ds_read_b64_tr_b16 v[92:93], v9 offset:7168
    ds_read_b64_tr_b16 v[94:95], v9 offset:7424
    v_max_f32 v52, 0, v52
    v_max_f32 v53, 0, v53
    v_max_f32 v54, 0, v54
    v_max_f32 v55, 0, v55
    v_mfma_f32_32x32x16_bf16 v[32:47], a[28:31], v[100:103], v[32:47]
    buffer_load_dwordx4 v[216:219], v3, s[8:11], s58 offen offset:1024 sc1
    s_waitcnt lgkmcnt(6)
    v_mfma_f32_32x32x16_bf16 v[16:31], a[32:35], v[80:83], v[16:31]
    ds_read_b64_tr_b16 v[96:97], v9 offset:8192
    ds_read_b64_tr_b16 v[98:99], v9 offset:8448
    v_mul_f32 v48, v48, v56
    v_mul_f32 v49, v49, v57
    v_mul_f32 v50, v50, v58
    v_mul_f32 v51, v51, v59
    v_mfma_f32_32x32x16_bf16 v[32:47], a[36:39], v[80:83], v[32:47]
    buffer_load_dwordx4 v[220:223], v3, s[8:11], s58 offen offset:2048 sc1
    s_waitcnt lgkmcnt(6)
    v_mfma_f32_32x32x16_bf16 v[16:31], a[40:43], v[84:87], v[16:31]
    ds_read_b64_tr_b16 v[100:101], v9 offset:9216
    ds_read_b64_tr_b16 v[102:103], v9 offset:9472
    v_mul_f32 v52, v52, v60
    v_mul_f32 v53, v53, v61
    v_mul_f32 v54, v54, v62
    v_mul_f32 v55, v55, v63
    v_mfma_f32_32x32x16_bf16 v[32:47], a[44:47], v[84:87], v[32:47]
    buffer_load_dwordx4 v[224:227], v3, s[8:11], s58 offen offset:3072 sc1
    s_waitcnt lgkmcnt(6)
    v_mfma_f32_32x32x16_bf16 v[16:31], a[48:51], v[88:91], v[16:31]
    ds_read_b64_tr_b16 v[80:81], v9 offset:10240
    ds_read_b64_tr_b16 v[82:83], v9 offset:10496
    v_cvt_pk_bf16_f32 v120, v48, v49
    v_cvt_pk_bf16_f32 v121, v50, v51
    v_cvt_pk_bf16_f32 v122, v52, v53
    v_cvt_pk_bf16_f32 v123, v54, v55
    v_mfma_f32_32x32x16_bf16 v[32:47], a[52:55], v[88:91], v[32:47]
    buffer_store_dwordx4 v[120:123], v3, s[8:11], s37 offen offset:0 sc1
    s_waitcnt lgkmcnt(6)
    v_mfma_f32_32x32x16_bf16 v[16:31], a[56:59], v[92:95], v[16:31]
    ds_read_b64_tr_b16 v[84:85], v9 offset:11264
    ds_read_b64_tr_b16 v[86:87], v9 offset:11520
    v_max_f32 v64, 0, v64
    v_max_f32 v65, 0, v65
    v_max_f32 v66, 0, v66
    v_max_f32 v67, 0, v67
    v_mfma_f32_32x32x16_bf16 v[32:47], a[60:63], v[92:95], v[32:47]
    s_add_u32 s58, s58, 4096
    buffer_load_dwordx4 v[228:231], v3, s[8:11], s58 offen offset:0 sc1
    s_waitcnt lgkmcnt(6)
    v_mfma_f32_32x32x16_bf16 v[16:31], a[64:67], v[96:99], v[16:31]
    ds_read_b64_tr_b16 v[88:89], v9 offset:12288
    ds_read_b64_tr_b16 v[90:91], v9 offset:12544
    v_max_f32 v68, 0, v68
    v_max_f32 v69, 0, v69
    v_max_f32 v70, 0, v70
    v_max_f32 v71, 0, v71
    v_mfma_f32_32x32x16_bf16 v[32:47], a[68:71], v[96:99], v[32:47]
    buffer_load_dwordx4 v[232:235], v3, s[8:11], s58 offen offset:1024 sc1
    s_waitcnt lgkmcnt(6)
    v_mfma_f32_32x32x16_bf16 v[16:31], a[72:75], v[100:103], v[16:31]
    ds_read_b64_tr_b16 v[92:93], v9 offset:13312
    ds_read_b64_tr_b16 v[94:95], v9 offset:13568
    v_mul_f32 v64, v64, v72
    v_mul_f32 v65, v65, v73
    v_mul_f32 v66, v66, v74
    v_mul_f32 v67, v67, v75
    v_mfma_f32_32x32x16_bf16 v[32:47], a[76:79], v[100:103], v[32:47]
    buffer_load_dwordx4 v[236:239], v3, s[8:11], s58 offen offset:2048 sc1
    s_waitcnt lgkmcnt(6)
    v_mfma_f32_32x32x16_bf16 v[16:31], a[80:83], v[80:83], v[16:31]
    ds_read_b64_tr_b16 v[96:97], v9 offset:14336
    ds_read_b64_tr_b16 v[98:99], v9 offset:14592
    v_mul_f32 v68, v68, v76
    v_mul_f32 v69, v69, v77
    v_mul_f32 v70, v70, v78
    v_mul_f32 v71, v71, v79
    v_mfma_f32_32x32x16_bf16 v[32:47], a[84:87], v[80:83], v[32:47]
    buffer_load_dwordx4 v[240:243], v3, s[8:11], s58 offen offset:3072 sc1
    s_waitcnt lgkmcnt(6)
    v_mfma_f32_32x32x16_bf16 v[16:31], a[88:91], v[84:87], v[16:31]
    ds_read_b64_tr_b16 v[100:101], v9 offset:15360
    ds_read_b64_tr_b16 v[102:103], v9 offset:15616
    v_cvt_pk_bf16_f32 v124, v64, v65
    v_cvt_pk_bf16_f32 v125, v66, v67
    v_cvt_pk_bf16_f32 v126, v68, v69
    v_cvt_pk_bf16_f32 v127, v70, v71
    v_mfma_f32_32x32x16_bf16 v[32:47], a[92:95], v[84:87], v[32:47]
    buffer_store_dwordx4 v[124:127], v3, s[8:11], s37 offen offset:1024 sc1
    s_waitcnt lgkmcnt(6)
    v_mfma_f32_32x32x16_bf16 v[16:31], a[96:99], v[88:91], v[16:31]
    ds_read_b64_tr_b16 v[80:81], v9 offset:16384
    ds_read_b64_tr_b16 v[82:83], v9 offset:16640
    v_mfma_f32_32x32x16_bf16 v[32:47], a[100:103], v[88:91], v[32:47]
    buffer_load_dwordx2 v[108:109], v5, s[8:11], s66 offen sc1
    s_waitcnt lgkmcnt(6)
    v_mfma_f32_32x32x16_bf16 v[16:31], a[104:107], v[92:95], v[16:31]
    ds_read_b64_tr_b16 v[84:85], v9 offset:17408
    ds_read_b64_tr_b16 v[86:87], v9 offset:17664
    v_mfma_f32_32x32x16_bf16 v[32:47], a[108:111], v[92:95], v[32:47]
    buffer_load_dwordx2 v[110:111], v5, s[8:11], s67 offen sc1
    s_waitcnt lgkmcnt(6)
    v_mfma_f32_32x32x16_bf16 v[16:31], a[112:115], v[96:99], v[16:31]
    ds_read_b64_tr_b16 v[88:89], v9 offset:18432
    ds_read_b64_tr_b16 v[90:91], v9 offset:18688
    v_mfma_f32_32x32x16_bf16 v[32:47], a[116:119], v[96:99], v[32:47]
    buffer_load_dwordx4 v[244:247], v3, s[8:11], s59 offen offset:0 sc1
    s_waitcnt lgkmcnt(6)
    v_mfma_f32_32x32x16_bf16 v[16:31], a[120:123], v[100:103], v[16:31]
    ds_read_b64_tr_b16 v[92:93], v9 offset:19456
    ds_read_b64_tr_b16 v[94:95], v9 offset:19712
    v_mfma_f32_32x32x16_bf16 v[32:47], a[124:127], v[100:103], v[32:47]
    buffer_load_dwordx4 v[248:251], v3, s[8:11], s59 offen offset:1024 sc1
    s_waitcnt lgkmcnt(6)
    v_mfma_f32_32x32x16_bf16 v[16:31], a[128:131], v[80:83], v[16:31]
    ds_read_b64_tr_b16 v[96:97], v9 offset:20480
    ds_read_b64_tr_b16 v[98:99], v9 offset:20736
    v_mfma_f32_32x32x16_bf16 v[32:47], a[132:135], v[80:83], v[32:47]
    buffer_load_dwordx4 v[252:255], v3, s[8:11], s59 offen offset:2048 sc1
    s_waitcnt lgkmcnt(6)
    v_mfma_f32_32x32x16_bf16 v[16:31], a[136:139], v[84:87], v[16:31]
    ds_read_b64_tr_b16 v[100:101], v9 offset:21504
    ds_read_b64_tr_b16 v[102:103], v9 offset:21760
    v_mfma_f32_32x32x16_bf16 v[32:47], a[140:143], v[84:87], v[32:47]
    buffer_load_dwordx4 a[224:227], v3, s[8:11], s59 offen offset:3072 sc1
    s_waitcnt lgkmcnt(6)
    v_mfma_f32_32x32x16_bf16 v[16:31], a[144:147], v[88:91], v[16:31]
    ds_read_b64_tr_b16 v[80:81], v9 offset:22528
    ds_read_b64_tr_b16 v[82:83], v9 offset:22784
    v_mfma_f32_32x32x16_bf16 v[32:47], a[148:151], v[88:91], v[32:47]
    s_add_u32 s59, s59, 4096
    buffer_load_dwordx4 a[228:231], v3, s[8:11], s59 offen offset:0 sc1
    s_waitcnt lgkmcnt(6)
    v_mfma_f32_32x32x16_bf16 v[16:31], a[152:155], v[92:95], v[16:31]
    ds_read_b64_tr_b16 v[84:85], v9 offset:23552
    ds_read_b64_tr_b16 v[86:87], v9 offset:23808
    s_waitcnt vmcnt(21)
    buffer_atomic_add v128, v129, s[8:11], s55 offen offset:0 sc1
    v_mfma_f32_32x32x16_bf16 v[32:47], a[156:159], v[92:95], v[32:47]
    buffer_load_dwordx4 a[232:235], v3, s[8:11], s59 offen offset:1024 sc1
    s_waitcnt lgkmcnt(6)
    v_mfma_f32_32x32x16_bf16 v[16:31], a[160:163], v[96:99], v[16:31]
    ds_read_b64_tr_b16 v[88:89], v9 offset:24576
    ds_read_b64_tr_b16 v[90:91], v9 offset:24832
    v_mfma_f32_32x32x16_bf16 v[32:47], a[164:167], v[96:99], v[32:47]
    buffer_load_dwordx4 a[236:239], v3, s[8:11], s59 offen offset:2048 sc1
    s_waitcnt lgkmcnt(6)
    v_mfma_f32_32x32x16_bf16 v[16:31], a[168:171], v[100:103], v[16:31]
    ds_read_b64_tr_b16 v[92:93], v9 offset:25600
    ds_read_b64_tr_b16 v[94:95], v9 offset:25856
    v_mfma_f32_32x32x16_bf16 v[32:47], a[172:175], v[100:103], v[32:47]
    buffer_load_dwordx4 a[240:243], v3, s[8:11], s59 offen offset:3072 sc1
    s_waitcnt lgkmcnt(6)
    v_mfma_f32_32x32x16_bf16 v[16:31], a[176:179], v[80:83], v[16:31]
    ds_read_b64_tr_b16 v[96:97], v9 offset:26624
    ds_read_b64_tr_b16 v[98:99], v9 offset:26880
    v_mfma_f32_32x32x16_bf16 v[32:47], a[180:183], v[80:83], v[32:47]
    s_add_u32 s59, s59, 4096
    buffer_load_dwordx4 a[244:247], v3, s[8:11], s59 offen offset:0 sc1
    s_waitcnt lgkmcnt(6)
    v_mfma_f32_32x32x16_bf16 v[16:31], a[184:187], v[84:87], v[16:31]
    ds_read_b64_tr_b16 v[100:101], v9 offset:27648
    ds_read_b64_tr_b16 v[102:103], v9 offset:27904
    v_mfma_f32_32x32x16_bf16 v[32:47], a[188:191], v[84:87], v[32:47]
    buffer_load_dwordx4 a[248:251], v3, s[8:11], s59 offen offset:1024 sc1
    s_waitcnt lgkmcnt(6)
    v_mfma_f32_32x32x16_bf16 v[16:31], a[192:195], v[88:91], v[16:31]
    s_barrier
    ds_read_b64_tr_b16 v[80:81], v9 offset:28672
    ds_read_b64_tr_b16 v[82:83], v9 offset:28928
    v_mfma_f32_32x32x16_bf16 v[32:47], a[196:199], v[88:91], v[32:47]
    buffer_load_dwordx4 a[252:255], v3, s[8:11], s59 offen offset:2048 sc1
    s_waitcnt lgkmcnt(6)
    v_mfma_f32_32x32x16_bf16 v[16:31], a[200:203], v[92:95], v[16:31]
    ds_read_b64_tr_b16 v[84:85], v9 offset:29696
    ds_read_b64_tr_b16 v[86:87], v9 offset:29952
    v_mfma_f32_32x32x16_bf16 v[32:47], a[204:207], v[92:95], v[32:47]
    s_waitcnt lgkmcnt(6)
    v_mfma_f32_32x32x16_bf16 v[16:31], a[208:211], v[96:99], v[16:31]
    ds_read_b64_tr_b16 v[88:89], v9 offset:30720
    ds_read_b64_tr_b16 v[90:91], v9 offset:30976
    s_waitcnt vmcnt(14)
    buffer_atomic_add v128, v129, s[8:11], s55 offen offset:128 sc1
    v_mfma_f32_32x32x16_bf16 v[32:47], a[212:215], v[96:99], v[32:47]
    s_waitcnt lgkmcnt(6)
    v_mfma_f32_32x32x16_bf16 v[16:31], a[216:219], v[100:103], v[16:31]
    ds_read_b64_tr_b16 v[92:93], v9 offset:31744
    ds_read_b64_tr_b16 v[94:95], v9 offset:32000
    s_waitcnt vmcnt(13)
    v_min_u32 v130, v109, v111
    v_cmp_eq_u32 vcc, 0, v130
    s_nop 1
    s_cmp_lg_u32 vcc_lo, 0
    s_cbranch_scc1 k_slow_rk2
k_ok_rk2:
    v_mfma_f32_32x32x16_bf16 v[32:47], a[220:223], v[100:103], v[32:47]
    v_mfma_f32_32x32x8_bf16 v[16:31], v[112:113], v[108:109], v[16:31]
    v_mfma_f32_32x32x8_bf16 v[32:47], v[116:117], v[108:109], v[32:47]
    s_waitcnt lgkmcnt(6)
    v_mfma_f32_32x32x16_bf16 v[48:63], a[0:3], v[80:83], 0
    ds_read_b64_tr_b16 v[96:97], v9 offset:32768
    ds_read_b64_tr_b16 v[98:99], v9 offset:33024
    v_mfma_f32_32x32x16_bf16 v[64:79], a[4:7], v[80:83], 0
    buffer_load_dwordx4 a[0:3], v3, s[8:11], s59 offen offset:3072 sc1
    s_waitcnt lgkmcnt(6)
    v_mfma_f32_32x32x16_bf16 v[48:63], a[8:11], v[84:87], v[48:63]
    ds_read_b64_tr_b16 v[100:101], v9 offset:33792
    ds_read_b64_tr_b16 v[102:103], v9 offset:34048
    v_mfma_f32_32x32x16_bf16 v[64:79], a[12:15], v[84:87], v[64:79]
    buffer_load_dword v10, v6, s[8:11], s46 offen offset:0 sc1
    s_waitcnt lgkmcnt(6)
    v_mfma_f32_32x32x16_bf16 v[48:63], a[16:19], v[88:91], v[48:63]
    ds_read_b64_tr_b16 v[80:81], v9 offset:34816
    ds_read_b64_tr_b16 v[82:83], v9 offset:35072
    v_max_f32 v16, 0, v16
    v_max_f32 v17, 0, v17
    v_max_f32 v18, 0, v18
    v_max_f32 v19, 0, v19
    v_mfma_f32_32x32x16_bf16 v[64:79], a[20:23], v[88:91], v[64:79]
    buffer_load_dword v11, v6, s[8:11], s46 offen offset:16 sc1
    s_waitcnt lgkmcnt(6)
    v_mfma_f32_32x32x16_bf16 v[48:63], a[24:27], v[92:95], v[48:63]
    ds_read_b64_tr_b16 v[84:85], v9 offset:35840
    ds_read_b64_tr_b16 v[86:87], v9 offset:36096
    v_max_f32 v20, 0, v20
    v_max_f32 v21, 0, v21
    v_max_f32 v22, 0, v22
    v_max_f32 v23, 0, v23
    v_mfma_f32_32x32x16_bf16 v[64:79], a[28:31], v[92:95], v[64:79]
    buffer_load_dword v12, v6, s[8:11], s46 offen offset:32 sc1
    s_waitcnt lgkmcnt(6)
    v_mfma_f32_32x32x16_bf16 v[48:63], a[32:35], v[96:99], v[48:63]
    ds_read_b64_tr_b16 v[88:89], v9 offset:36864
    ds_read_b64_tr_b16 v[90:91], v9 offset:37120
    v_mul_f32 v16, v16, v24
    v_mul_f32 v17, v17, v25
    v_mul_f32 v18, v18, v26
    v_mul_f32 v19, v19, v27
    v_mfma_f32_32x32x16_bf16 v[64:79], a[36:39], v[96:99], v[64:79]
    buffer_load_dword v13, v6, s[8:11], s46 offen offset:48 sc1
    s_waitcnt lgkmcnt(6)
    v_mfma_f32_32x32x16_bf16 v[48:63], a[40:43], v[100:103], v[48:63]
    ds_read_b64_tr_b16 v[92:93], v9 offset:37888
    ds_read_b64_tr_b16 v[94:95], v9 offset:38144
    s_mov_b32 s68, 0
    s_load_dword s68, s[8:9], s55 glc
    v_mul_f32 v20, v20, v28
    v_mul_f32 v21, v21, v29
    v_mul_f32 v22, v22, v30
    v_mul_f32 v23, v23, v31
    v_mfma_f32_32x32x16_bf16 v[64:79], a[44:47], v[100:103], v[64:79]
    buffer_load_dword v14, v4, s[8:11], s64 offen offset:4 sc1
    s_waitcnt lgkmcnt(6)
    v_mfma_f32_32x32x16_bf16 v[48:63], a[48:51], v[80:83], v[48:63]
    ds_read_b64_tr_b16 v[96:97], v9 offset:38912
    ds_read_b64_tr_b16 v[98:99], v9 offset:39168
    v_cvt_pk_bf16_f32 v120, v16, v17
    v_cvt_pk_bf16_f32 v121, v18, v19
    v_cvt_pk_bf16_f32 v122, v20, v21
    v_cvt_pk_bf16_f32 v123, v22, v23
    v_mfma_f32_32x32x16_bf16 v[64:79], a[52:55], v[80:83], v[64:79]
    buffer_store_dwordx4 v[120:123], v3, s[8:11], s38 offen offset:0 sc1
    s_waitcnt lgkmcnt(6)
    v_mfma_f32_32x32x16_bf16 v[48:63], a[56:59], v[84:87], v[48:63]
    ds_read_b64_tr_b16 v[100:101], v9 offset:39936
    ds_read_b64_tr_b16 v[102:103], v9 offset:40192
    v_max_f32 v32, 0, v32
    v_max_f32 v33, 0, v33
    v_max_f32 v34, 0, v34
    v_max_f32 v35, 0, v35
    v_mfma_f32_32x32x16_bf16 v[64:79], a[60:63], v[84:87], v[64:79]
    buffer_load_dword v15, v4, s[8:11], s66 offen offset:4 sc1
    s_waitcnt lgkmcnt(6)
    v_mfma_f32_32x32x16_bf16 v[48:63], a[64:67], v[88:91], v[48:63]
    ds_read_b64_tr_b16 v[80:81], v9 offset:40960
    ds_read_b64_tr_b16 v[82:83], v9 offset:41216
    v_max_f32 v36, 0, v36
    v_max_f32 v37, 0, v37
    v_max_f32 v38, 0, v38
    v_max_f32 v39, 0, v39
    v_mfma_f32_32x32x16_bf16 v[64:79], a[68:71], v[88:91], v[64:79]
    s_add_u32 s59, s59, 4096
    buffer_load_dwordx4 a[4:7], v3, s[8:11], s59 offen offset:0 sc1
    s_waitcnt lgkmcnt(6)
    v_mfma_f32_32x32x16_bf16 v[48:63], a[72:75], v[92:95], v[48:63]
    ds_read_b64_tr_b16 v[84:85], v9 offset:41984
    ds_read_b64_tr_b16 v[86:87], v9 offset:42240
    v_mul_f32 v32, v32, v40
    v_mul_f32 v33, v33, v41
    v_mul_f32 v34, v34, v42
    v_mul_f32 v35, v35, v43
    v_mfma_f32_32x32x16_bf16 v[64:79], a[76:79], v[92:95], v[64:79]
    buffer_load_dwordx4 a[8:11], v3, s[8:11], s59 offen offset:1024 sc1
    s_waitcnt lgkmcnt(6)
    v_mfma_f32_32x32x16_bf16 v[48:63], a[80:83], v[96:99], v[48:63]
    ds_read_b64_tr_b16 v[88:89], v9 offset:43008
    ds_read_b64_tr_b16 v[90:91], v9 offset:43264
    v_mul_f32 v36, v36, v44
    v_mul_f32 v37, v37, v45
    v_mul_f32 v38, v38, v46
    v_mul_f32 v39, v39, v47
    v_mfma_f32_32x32x16_bf16 v[64:79], a[84:87], v[96:99], v[64:79]
    buffer_load_dwordx4 a[12:15], v3, s[8:11], s59 offen offset:2048 sc1
    s_waitcnt lgkmcnt(6)
    v_mfma_f32_32x32x16_bf16 v[48:63], a[88:91], v[100:103], v[48:63]
    ds_read_b64_tr_b16 v[92:93], v9 offset:44032
    ds_read_b64_tr_b16 v[94:95], v9 offset:44288
    v_cvt_pk_bf16_f32 v124, v32, v33
    v_cvt_pk_bf16_f32 v125, v34, v35
    v_cvt_pk_bf16_f32 v126, v36, v37
    v_cvt_pk_bf16_f32 v127, v38, v39
    v_mfma_f32_32x32x16_bf16 v[64:79], a[92:95], v[100:103], v[64:79]
    buffer_store_dwordx4 v[124:127], v3, s[8:11], s38 offen offset:1024 sc1
    s_waitcnt lgkmcnt(6)
    v_mfma_f32_32x32x16_bf16 v[48:63], a[96:99], v[80:83], v[48:63]
    ds_read_b64_tr_b16 v[96:97], v9 offset:45056
    ds_read_b64_tr_b16 v[98:99], v9 offset:45312
    v_mfma_f32_32x32x16_bf16 v[64:79], a[100:103], v[80:83], v[64:79]
    buffer_load_dwordx4 a[16:19], v3, s[8:11], s59 offen offset:3072 sc1
    s_waitcnt lgkmcnt(6)
    v_mfma_f32_32x32x16_bf16 v[48:63], a[104:107], v[84:87], v[48:63]
    ds_read_b64_tr_b16 v[100:101], v9 offset:46080
    ds_read_b64_tr_b16 v[102:103], v9 offset:46336
    v_mfma_f32_32x32x16_bf16 v[64:79], a[108:111], v[84:87], v[64:79]
    s_add_u32 s59, s59, 4096
    buffer_load_dwordx4 a[20:23], v3, s[8:11], s59 offen offset:0 sc1
    s_waitcnt lgkmcnt(6)
    v_mfma_f32_32x32x16_bf16 v[48:63], a[112:115], v[88:91], v[48:63]
    ds_read_b64_tr_b16 v[80:81], v9 offset:47104
    ds_read_b64_tr_b16 v[82:83], v9 offset:47360
    s_cmp_lt_u32 s68, 7
    s_cbranch_scc1 k_slow_p0
k_ok_p0:
    v_mfma_f32_32x32x16_bf16 v[64:79], a[116:119], v[88:91], v[64:79]
    buffer_load_dwordx4 a[24:27], v3, s[8:11], s60 offen offset:0 sc1
    s_waitcnt lgkmcnt(6)
    v_mfma_f32_32x32x16_bf16 v[48:63], a[120:123], v[92:95], v[48:63]
    ds_read_b64_tr_b16 v[84:85], v9 offset:48128
    ds_read_b64_tr_b16 v[86:87], v9 offset:48384
    v_mfma_f32_32x32x16_bf16 v[64:79], a[124:127], v[92:95], v[64:79]
    buffer_load_dwordx4 a[28:31], v3, s[8:11], s60 offen offset:1024 sc1
    s_waitcnt lgkmcnt(6)
    v_mfma_f32_32x32x16_bf16 v[48:63], a[128:131], v[96:99], v[48:63]
    ds_read_b64_tr_b16 v[88:89], v9 offset:49152
    ds_read_b64_tr_b16 v[90:91], v9 offset:49408
    v_mfma_f32_32x32x16_bf16 v[64:79], a[132:135], v[96:99], v[64:79]
    buffer_load_dwordx4 a[32:35], v3, s[8:11], s60 offen offset:2048 sc1
    s_waitcnt lgkmcnt(6)
    v_mfma_f32_32x32x16_bf16 v[48:63], a[136:139], v[100:103], v[48:63]
    ds_read_b64_tr_b16 v[92:93], v9 offset:50176
    ds_read_b64_tr_b16 v[94:95], v9 offset:50432
    v_mfma_f32_32x32x16_bf16 v[64:79], a[140:143], v[100:103], v[64:79]
    buffer_load_dwordx4 a[36:39], v3, s[8:11], s60 offen offset:3072 sc1
    s_waitcnt lgkmcnt(6)
    v_mfma_f32_32x32x16_bf16 v[48:63], a[144:147], v[80:83], v[48:63]
    ds_read_b64_tr_b16 v[96:97], v9 offset:51200
    ds_read_b64_tr_b16 v[98:99], v9 offset:51456
    v_mfma_f32_32x32x16_bf16 v[64:79], a[148:151], v[80:83], v[64:79]
    s_add_u32 s60, s60, 4096
    buffer_load_dwordx4 a[40:43], v3, s[8:11], s60 offen offset:0 sc1
    s_waitcnt lgkmcnt(6)
    v_mfma_f32_32x32x16_bf16 v[48:63], a[152:155], v[84:87], v[48:63]
    ds_read_b64_tr_b16 v[100:101], v9 offset:52224
    ds_read_b64_tr_b16 v[102:103], v9 offset:52480
    v_mfma_f32_32x32x16_bf16 v[64:79], a[156:159], v[84:87], v[64:79]
    buffer_load_dwordx4 a[44:47], v3, s[8:11], s60 offen offset:1024 sc1
    s_waitcnt lgkmcnt(6)
    v_mfma_f32_32x32x16_bf16 v[48:63], a[160:163], v[88:91], v[48:63]
    ds_read_b64_tr_b16 v[80:81], v9 offset:53248
    ds_read_b64_tr_b16 v[82:83], v9 offset:53504
    v_mfma_f32_32x32x16_bf16 v[64:79], a[164:167], v[88:91], v[64:79]
    buffer_load_dwordx4 a[48:51], v3, s[8:11], s60 offen offset:2048 sc1
    s_waitcnt lgkmcnt(6)
    v_mfma_f32_32x32x16_bf16 v[48:63], a[168:171], v[92:95], v[48:63]
    ds_read_b64_tr_b16 v[84:85], v9 offset:54272
    ds_read_b64_tr_b16 v[86:87], v9 offset:54528
    v_mfma_f32_32x32x16_bf16 v[64:79], a[172:175], v[92:95], v[64:79]
    buffer_load_dwordx4 a[52:55], v3, s[8:11], s60 offen offset:3072 sc1
    s_waitcnt lgkmcnt(6)
    v_mfma_f32_32x32x16_bf16 v[48:63], a[176:179], v[96:99], v[48:63]
    ds_read_b64_tr_b16 v[88:89], v9 offset:55296
    ds_read_b64_tr_b16 v[90:91], v9 offset:55552
    v_mfma_f32_32x32x16_bf16 v[64:79], a[180:183], v[96:99], v[64:79]
    s_add_u32 s60, s60, 4096
    buffer_load_dwordx4 a[56:59], v3, s[8:11], s60 offen offset:0 sc1
    s_waitcnt lgkmcnt(6)
    v_mfma_f32_32x32x16_bf16 v[48:63], a[184:187], v[100:103], v[48:63]
    ds_read_b64_tr_b16 v[92:93], v9 offset:56320
    ds_read_b64_tr_b16 v[94:95], v9 offset:56576
    v_mfma_f32_32x32x16_bf16 v[64:79], a[188:191], v[100:103], v[64:79]
    buffer_load_dwordx4 a[60:63], v3, s[8:11], s60 offen offset:1024 sc1
    s_waitcnt lgkmcnt(6)
    v_mfma_f32_32x32x16_bf16 v[48:63], a[192:195], v[80:83], v[48:63]
    v_mfma_f32_32x32x16_bf16 v[64:79], a[196:199], v[80:83], v[64:79]
    buffer_load_dwordx4 a[64:67], v3, s[8:11], s60 offen offset:2048 sc1
    s_waitcnt lgkmcnt(4)
    v_mfma_f32_32x32x16_bf16 v[48:63], a[200:203], v[84:87], v[48:63]
    v_mfma_f32_32x32x16_bf16 v[64:79], a[204:207], v[84:87], v[64:79]
    buffer_load_dwordx4 a[68:71], v3, s[8:11], s60 offen offset:3072 sc1
    s_waitcnt lgkmcnt(2)
    v_mfma_f32_32x32x16_bf16 v[48:63], a[208:211], v[88:91], v[48:63]
    v_mfma_f32_32x32x16_bf16 v[64:79], a[212:215], v[88:91], v[64:79]
    s_add_u32 s60, s60, 4096
    buffer_load_dwordx4 a[72:75], v3, s[8:11], s60 offen offset:0 sc1
    s_waitcnt lgkmcnt(0)
    v_mfma_f32_32x32x16_bf16 v[48:63], a[216:219], v[92:95], v[48:63]
    v_mfma_f32_32x32x16_bf16 v[64:79], a[220:223], v[92:95], v[64:79]
    v_mfma_f32_32x32x8_bf16 v[48:63], v[112:113], v[110:111], v[48:63]
    v_mfma_f32_32x32x8_bf16 v[64:79], v[116:117], v[110:111], v[64:79]
    s_mov_b32 s69, 0
    s_load_dword s69, s[8:9], s56 glc
    s_waitcnt vmcnt(15)
    buffer_atomic_add v128, v129, s[8:11], s55 offen offset:256 sc1
    s_nop 9
    v_max_f32 v48, 0, v48
    v_max_f32 v49, 0, v49
    v_max_f32 v50, 0, v50
    v_max_f32 v51, 0, v51
    v_max_f32 v52, 0, v52
    v_max_f32 v53, 0, v53
    v_max_f32 v54, 0, v54
    v_max_f32 v55, 0, v55
    v_pk_mul_f32 v[48:49], v[48:49], v[56:57]
    v_pk_mul_f32 v[50:51], v[50:51], v[58:59]
    v_pk_mul_f32 v[52:53], v[52:53], v[60:61]
    v_pk_mul_f32 v[54:55], v[54:55], v[62:63]
    v_cvt_pk_bf16_f32 v120, v48, v49
    v_cvt_pk_bf16_f32 v121, v50, v51
    v_cvt_pk_bf16_f32 v122, v52, v53
    v_cvt_pk_bf16_f32 v123, v54, v55
    buffer_store_dwordx4 v[120:123], v3, s[8:11], s39 offen offset:0 sc1
    v_max_f32 v64, 0, v64
    v_max_f32 v65, 0, v65
    v_max_f32 v66, 0, v66
    v_max_f32 v67, 0, v67
    v_max_f32 v68, 0, v68
    v_max_f32 v69, 0, v69
    v_max_f32 v70, 0, v70
    v_max_f32 v71, 0, v71
    v_pk_mul_f32 v[64:65], v[64:65], v[72:73]
    v_pk_mul_f32 v[66:67], v[66:67], v[74:75]
    v_pk_mul_f32 v[68:69], v[68:69], v[76:77]
    v_pk_mul_f32 v[70:71], v[70:71], v[78:79]
    v_cvt_pk_bf16_f32 v124, v64, v65
    v_cvt_pk_bf16_f32 v125, v66, v67
    v_cvt_pk_bf16_f32 v126, v68, v69
    v_cvt_pk_bf16_f32 v127, v70, v71
    buffer_store_dwordx4 v[124:127], v3, s[8:11], s39 offen offset:1024 sc1
    s_waitcnt vmcnt(15)
    v_mfma_f32_32x32x16_bf16 v[16:31], v[132:135], a[24:27], 0
    v_bfe_u32 v4, v2, 4, 1
    v_and_b32 v5, 3, v2
    v_lshl_add_u32 v4, v4, 2, v5
    v_bfe_u32 v6, v2, 2, 2
    v_lshl_add_u32 v4, v4, 3, v6
    v_mfma_f32_32x32x16_bf16 v[32:47], v[136:139], a[24:27], 0
    v_lshrrev_b32 v6, 5, v0
    v_lshlrev_b32 v6, 3, v6
    v_lshl_add_u32 v4, v4, 6, v6
    v_add_u32 v4, 147456, v4
    ds_read_b64_tr_b16 v[120:121], v4 offset:0
    s_waitcnt vmcnt(14)
    v_mfma_f32_32x32x16_bf16 v[16:31], v[140:143], a[28:31], v[16:31]
    buffer_load_dwordx4 a[24:27], v3, s[8:11], s60 offen offset:1024 sc1
    v_mfma_f32_32x32x16_bf16 v[32:47], v[144:147], a[28:31], v[32:47]
    ds_read_b64_tr_b16 v[122:123], v4 offset:256
    ds_read_b64_tr_b16 v[124:125], v4 offset:4096
    ds_read_b64_tr_b16 v[126:127], v4 offset:4352
    v_lshrrev_b32 v6, 5, v2
    v_lshl_add_u32 v5, v6, 2, v5
    s_waitcnt vmcnt(14)
    v_mfma_f32_32x32x16_bf16 v[16:31], v[148:151], a[32:35], v[16:31]
    s_waitcnt lgkmcnt(0)
    s_cmp_lt_u32 s69, 7
    s_cbranch_scc1 k_slow_p1
k_ok_p1:
    buffer_load_dwordx4 a[28:31], v3, s[8:11], s61 offen offset:0 sc1
    v_mfma_f32_32x32x16_bf16 v[32:47], v[152:155], a[32:35], v[32:47]
    v_bfe_u32 v7, v2, 2, 3
    v_lshlrev_b32 v7, 4, v7
    v_lshl_add_u32 v5, v5, 7, v7
    s_lshl_b32 s21, s23, 11
    s_add_u32 s21, s21, 155648
    s_waitcnt vmcnt(14)
    v_mfma_f32_32x32x16_bf16 v[16:31], v[156:159], a[36:39], v[16:31]
    buffer_load_dwordx4 a[32:35], v3, s[8:11], s61 offen offset:1024 sc1
    v_mfma_f32_32x32x16_bf16 v[32:47], v[160:163], a[36:39], v[32:47]
    v_add_u32 v5, s21, v5
    v_add_u32 v7, s21, v3
    v_lshlrev_b32 v80, 16, v10
    v_and_b32 v81, 0xffff0000, v10
    s_waitcnt vmcnt(14)
    v_mfma_f32_32x32x16_bf16 v[16:31], v[164:167], a[40:43], v[16:31]
    buffer_load_dwordx4 a[36:39], v3, s[8:11], s61 offen offset:2048 sc1
    v_mfma_f32_32x32x16_bf16 v[32:47], v[168:171], a[40:43], v[32:47]
    v_lshlrev_b32 v82, 16, v11
    v_and_b32 v83, 0xffff0000, v11
    v_lshlrev_b32 v84, 16, v12
    v_and_b32 v85, 0xffff0000, v12
    v_lshlrev_b32 v86, 16, v13
    s_waitcnt vmcnt(14)
    v_mfma_f32_32x32x16_bf16 v[16:31], v[172:175], a[44:47], v[16:31]
    buffer_load_dwordx4 a[40:43], v3, s[8:11], s61 offen offset:3072 sc1
    v_mfma_f32_32x32x16_bf16 v[32:47], v[176:179], a[44:47], v[32:47]
    v_and_b32 v87, 0xffff0000, v13
    v_and_b32 v14, 0xffff0000, v14
    v_and_b32 v15, 0xffff0000, v15
    v_mul_f32 v14, v14, v14
    v_mul_f32 v15, v15, v15
    s_waitcnt vmcnt(14)
    v_mfma_f32_32x32x16_bf16 v[16:31], v[180:183], a[48:51], v[16:31]
    s_add_u32 s61, s61, 4096
    buffer_load_dwordx4 a[44:47], v3, s[8:11], s61 offen offset:0 sc1
    v_mfma_f32_32x32x16_bf16 v[32:47], v[184:187], a[48:51], v[32:47]
    v_rcp_f32 v14, v14
    v_rcp_f32 v15, v15
    ds_write_b128 v5, v[120:123] offset:0
    ds_write_b128 v5, v[124:127] offset:1024
    s_waitcnt vmcnt(14)
    v_mfma_f32_32x32x16_bf16 v[16:31], v[188:191], a[52:55], v[16:31]
    buffer_load_dwordx4 a[48:51], v3, s[8:11], s61 offen offset:1024 sc1
    v_mfma_f32_32x32x16_bf16 v[32:47], v[192:195], a[52:55], v[32:47]
    ds_read_b128 v[120:123], v7 offset:0
    ds_read_b128 v[124:127], v7 offset:1024
    v_mul_f32 v88, v80, v14
    v_mul_f32 v89, v81, v14
    v_mul_f32 v90, v82, v14
    s_waitcnt vmcnt(14)
    v_mfma_f32_32x32x16_bf16 v[16:31], v[196:199], a[56:59], v[16:31]
    buffer_load_dwordx4 a[52:55], v3, s[8:11], s61 offen offset:2048 sc1
    v_mfma_f32_32x32x16_bf16 v[32:47], v[200:203], a[56:59], v[32:47]
    v_mul_f32 v91, v83, v14
    v_mul_f32 v92, v84, v14
    v_mul_f32 v93, v85, v14
    v_mul_f32 v94, v86, v14
    v_mul_f32 v95, v87, v14
    s_waitcnt vmcnt(14)
    v_mfma_f32_32x32x16_bf16 v[16:31], v[204:207], a[60:63], v[16:31]
    buffer_load_dwordx4 a[56:59], v3, s[8:11], s61 offen offset:3072 sc1
    v_mfma_f32_32x32x16_bf16 v[32:47], v[208:211], a[60:63], v[32:47]
    v_mul_f32 v96, v80, v15
    v_mul_f32 v97, v81, v15
    v_mul_f32 v98, v82, v15
    v_mul_f32 v99, v83, v15
    v_mul_f32 v100, v84, v15
    s_waitcnt vmcnt(14)
    v_mfma_f32_32x32x16_bf16 v[16:31], v[212:215], a[64:67], v[16:31]
    buffer_load_dwordx4 a[60:63], v3, s[8:11], s59 offen offset:1024 sc1
    v_mfma_f32_32x32x16_bf16 v[32:47], v[216:219], a[64:67], v[32:47]
    v_mul_f32 v101, v85, v15
    v_mul_f32 v102, v86, v15
    v_mul_f32 v103, v87, v15
    v_and_b32 v8, 7, v2
    v_xor_b32 v10, v6, v8
    s_waitcnt vmcnt(14)
    v_mfma_f32_32x32x16_bf16 v[16:31], v[220:223], a[68:71], v[16:31]
    s_add_u32 s61, s61, 4096
    buffer_load_dwordx4 a[64:67], v3, s[8:11], s61 offen offset:0 sc1
    v_mfma_f32_32x32x16_bf16 v[32:47], v[224:227], a[68:71], v[32:47]
    v_lshlrev_b32 v10, 4, v10
    v_and_b32 v9, 31, v2
    v_lshl_add_u32 v10, v9, 8, v10
    s_lshl_b32 s21, s23, 13
    s_add_u32 s21, s21, 114688
    s_waitcnt vmcnt(14)
    v_mfma_f32_32x32x16_bf16 v[16:31], v[228:231], a[72:75], v[16:31]
    buffer_load_dwordx4 a[68:71], v3, s[8:11], s59 offen offset:2048 sc1
    v_mfma_f32_32x32x16_bf16 v[32:47], v[232:235], a[72:75], v[32:47]
    v_add_u32 v10, s21, v10
    v_xor_b32 v11, 32, v10
    v_xor_b32 v12, 64, v10
    v_xor_b32 v13, 0x60, v10
    v_lshlrev_b32 v8, 1, v8
    s_waitcnt vmcnt(11)
    buffer_atomic_add v128, v129, s[8:11], s55 offen offset:384 sc1
    v_mfma_f32_32x32x16_bf16 v[16:31], v[236:239], a[24:27], v[16:31]
    buffer_load_dwordx4 a[72:75], v3, s[8:11], s59 offen offset:3072 sc1
    v_mfma_f32_32x32x16_bf16 v[32:47], v[240:243], a[24:27], v[32:47]
    v_lshrrev_b32 v9, 3, v2
    v_xor_b32 v8, v8, v9
    v_lshlrev_b32 v8, 4, v8
    v_lshrrev_b32 v9, 3, v0
    v_lshl_add_u32 v8, v9, 8, v8
    s_waitcnt vmcnt(12)
    v_mfma_f32_32x32x16_bf16 v[16:31], v[244:247], a[28:31], v[16:31]
    buffer_load_dwordx4 a[24:27], v3, s[8:11], s61 offen offset:1024 sc1
    v_mfma_f32_32x32x16_bf16 v[32:47], v[248:251], a[28:31], v[32:47]
    v_add_u32 v8, 114688, v8
    v_xor_b32 v9, 16, v8
    s_waitcnt lgkmcnt(0)
    v_lshlrev_b32 v104, 16, v120
    v_and_b32 v105, 0xffff0000, v120
    s_waitcnt vmcnt(12)
    v_mfma_f32_32x32x16_bf16 v[16:31], v[252:255], a[32:35], v[16:31]
    s_add_u32 s59, s59, 4096
    buffer_load_dwordx4 a[28:31], v3, s[8:11], s59 offen offset:0 sc1
    v_mfma_f32_32x32x16_bf16 v[32:47], a[224:227], a[32:35], v[32:47]
    v_lshlrev_b32 v106, 16, v121
    v_and_b32 v107, 0xffff0000, v121
    v_lshlrev_b32 v108, 16, v122
    v_and_b32 v109, 0xffff0000, v122
    v_lshlrev_b32 v110, 16, v123
    s_waitcnt vmcnt(12)
    v_mfma_f32_32x32x16_bf16 v[16:31], a[228:231], a[36:39], v[16:31]
    buffer_load_dwordx4 a[32:35], v3, s[8:11], s59 offen offset:1024 sc1
    v_mfma_f32_32x32x16_bf16 v[32:47], a[232:235], a[36:39], v[32:47]
    v_and_b32 v111, 0xffff0000, v123
    v_lshlrev_b32 v112, 16, v124
    v_and_b32 v113, 0xffff0000, v124
    v_lshlrev_b32 v114, 16, v125
    v_and_b32 v115, 0xffff0000, v125
    s_waitcnt vmcnt(12)
    v_mfma_f32_32x32x16_bf16 v[16:31], a[236:239], a[40:43], v[16:31]
    buffer_load_dwordx4 a[36:39], v3, s[8:11], s61 offen offset:2048 sc1
    v_mfma_f32_32x32x16_bf16 v[32:47], a[240:243], a[40:43], v[32:47]
    v_lshlrev_b32 v116, 16, v126
    v_and_b32 v117, 0xffff0000, v126
    v_lshlrev_b32 v118, 16, v127
    v_and_b32 v119, 0xffff0000, v127
    s_waitcnt vmcnt(12)
    v_mfma_f32_32x32x16_bf16 v[16:31], a[244:247], a[44:47], v[16:31]
    buffer_load_dwordx4 a[40:43], v3, s[8:11], s59 offen offset:2048 sc1
    v_mfma_f32_32x32x16_bf16 v[32:47], a[248:251], a[44:47], v[32:47]
    s_waitcnt vmcnt(12)
    v_mfma_f32_32x32x16_bf16 v[16:31], a[252:255], a[48:51], v[16:31]
    buffer_load_dwordx4 a[44:47], v3, s[8:11], s59 offen offset:3072 sc1
    v_mfma_f32_32x32x16_bf16 v[32:47], a[0:3], a[48:51], v[32:47]
    s_waitcnt vmcnt(12)
    v_mfma_f32_32x32x16_bf16 v[16:31], a[4:7], a[52:55], v[16:31]
    buffer_load_dwordx4 a[48:51], v3, s[8:11], s61 offen offset:3072 sc1
    v_mfma_f32_32x32x16_bf16 v[32:47], a[8:11], a[52:55], v[32:47]
    s_waitcnt vmcnt(12)
    v_mfma_f32_32x32x16_bf16 v[16:31], a[12:15], a[56:59], v[16:31]
    s_mov_b32 s70, 0
    s_load_dword s70, s[8:9], s57 glc
    s_add_u32 s59, s59, 4096
    buffer_load_dwordx4 a[52:55], v3, s[8:11], s59 offen offset:0 sc1
    v_mfma_f32_32x32x16_bf16 v[32:47], a[16:19], a[56:59], v[32:47]
    buffer_load_dwordx4 a[76:79], v3, s[8:11], s59 offen offset:1024 sc1
    s_waitcnt vmcnt(12)
    v_mfma_f32_32x32x16_bf16 v[16:31], a[20:23], a[64:67], v[16:31]
    s_add_u32 s61, s61, 4096
    buffer_load_dwordx4 a[56:59], v3, s[8:11], s61 offen offset:0 sc1
    v_mfma_f32_32x32x16_bf16 v[32:47], a[60:63], a[64:67], v[32:47]
    buffer_load_dwordx4 a[80:83], v3, s[8:11], s59 offen offset:2048 sc1
    buffer_load_dwordx4 a[64:67], v3, s[8:11], s59 offen offset:3072 sc1
    s_waitcnt vmcnt(11)
    v_mfma_f32_32x32x16_bf16 v[16:31], a[68:71], a[24:27], v[16:31]
    buffer_load_dwordx4 a[84:87], v3, s[8:11], s61 offen offset:1024 sc1
    v_mfma_f32_32x32x16_bf16 v[32:47], a[72:75], a[24:27], v[32:47]
    s_waitcnt lgkmcnt(0)
    s_cmp_lt_u32 s70, 7
    s_cbranch_scc1 k_slow_p2
k_ok_p2:
    buffer_load_dwordx4 a[88:91], v3, s[8:11], s62 offen offset:0 sc1
    buffer_load_dwordx4 a[24:27], v3, s[8:11], s62 offen offset:1024 sc1
    s_waitcnt vmcnt(11)
    v_mfma_f32_32x32x16_bf16 v[16:31], a[28:31], a[36:39], v[16:31]
    buffer_load_dwordx4 a[92:95], v3, s[8:11], s62 offen offset:2048 sc1
    v_mfma_f32_32x32x16_bf16 v[32:47], a[32:35], a[36:39], v[32:47]
    buffer_load_dwordx4 a[96:99], v3, s[8:11], s62 offen offset:3072 sc1
    s_add_u32 s62, s62, 4096
    buffer_load_dwordx4 a[36:39], v3, s[8:11], s62 offen offset:0 sc1
    s_waitcnt vmcnt(11)
    v_mfma_f32_32x32x16_bf16 v[16:31], a[40:43], a[48:51], v[16:31]
    buffer_load_dwordx4 a[100:103], v3, s[8:11], s62 offen offset:1024 sc1
    v_mfma_f32_32x32x16_bf16 v[32:47], a[44:47], a[48:51], v[32:47]
    buffer_load_dwordx4 a[104:107], v3, s[8:11], s62 offen offset:2048 sc1
    buffer_load_dwordx4 a[48:51], v3, s[8:11], s62 offen offset:3072 sc1
    s_waitcnt vmcnt(11)
    v_mfma_f32_32x32x16_bf16 v[16:31], a[52:55], a[56:59], v[16:31]
    s_mov_b32 s71, 0
    s_load_dword s71, s[8:9], s7 glc
    s_add_u32 s62, s62, 4096
    buffer_load_dwordx4 a[108:111], v3, s[8:11], s62 offen offset:0 sc1
    v_mfma_f32_32x32x16_bf16 v[32:47], a[76:79], a[56:59], v[32:47]
    buffer_load_dwordx4 a[112:115], v3, s[8:11], s62 offen offset:1024 sc1
    buffer_load_dwordx4 a[56:59], v3, s[8:11], s62 offen offset:2048 sc1
    s_waitcnt vmcnt(11)
    v_mfma_f32_32x32x16_bf16 v[16:31], a[80:83], a[84:87], v[16:31]
    buffer_load_dwordx4 a[116:119], v3, s[8:11], s62 offen offset:3072 sc1
    v_mfma_f32_32x32x16_bf16 v[32:47], a[64:67], a[84:87], v[32:47]
    s_waitcnt vmcnt(11)
    v_mfma_f32_32x32x16_bf16 v[48:63], v[132:135], a[88:91], 0
    s_add_u32 s62, s62, 4096
    buffer_load_dwordx4 a[84:87], v3, s[8:11], s62 offen offset:0 sc1
    v_mfma_f32_32x32x16_bf16 v[64:79], v[136:139], a[88:91], 0
    s_waitcnt vmcnt(11)
    v_mfma_f32_32x32x16_bf16 v[48:63], v[140:143], a[24:27], v[48:63]
    buffer_load_dwordx4 v[132:135], v3, s[8:11], s62 offen offset:1024 sc1
    v_mfma_f32_32x32x16_bf16 v[64:79], v[144:147], a[24:27], v[64:79]
    s_waitcnt vmcnt(11)
    v_mfma_f32_32x32x16_bf16 v[48:63], v[148:151], a[92:95], v[48:63]
    s_waitcnt lgkmcnt(0)
    s_cmp_lt_u32 s71, 7
    s_cbranch_scc1 k_slow_p3
k_ok_p3:
    buffer_load_dwordx4 v[136:139], v3, s[8:11], s63 offen offset:0 sc1
    v_mfma_f32_32x32x16_bf16 v[64:79], v[152:155], a[92:95], v[64:79]
    s_waitcnt vmcnt(11)
    v_mfma_f32_32x32x16_bf16 v[48:63], v[156:159], a[96:99], v[48:63]
    buffer_load_dwordx4 v[140:143], v3, s[8:11], s63 offen offset:1024 sc1
    v_mfma_f32_32x32x16_bf16 v[64:79], v[160:163], a[96:99], v[64:79]
    ds_write_b128 v10, v[16:19] offset:0
    ds_write_b128 v11, v[20:23] offset:0
    ds_write_b128 v12, v[24:27] offset:0
    ds_write_b128 v13, v[28:31] offset:0
    ds_write_b128 v10, v[32:35] offset:128
    s_waitcnt vmcnt(11)
    v_mfma_f32_32x32x16_bf16 v[48:63], v[164:167], a[36:39], v[48:63]
    buffer_load_dwordx4 v[144:147], v3, s[8:11], s63 offen offset:2048 sc1
    v_mfma_f32_32x32x16_bf16 v[64:79], v[168:171], a[36:39], v[64:79]
    ds_write_b128 v11, v[36:39] offset:128
    ds_write_b128 v12, v[40:43] offset:128
    ds_write_b128 v13, v[44:47] offset:128
    s_waitcnt vmcnt(11)
    v_mfma_f32_32x32x16_bf16 v[48:63], v[172:175], a[100:103], v[48:63]
    buffer_load_dwordx4 v[148:151], v3, s[8:11], s63 offen offset:3072 sc1
    v_mfma_f32_32x32x16_bf16 v[64:79], v[176:179], a[100:103], v[64:79]
    s_waitcnt lgkmcnt(0)
    s_barrier
    s_waitcnt vmcnt(11)
    v_mfma_f32_32x32x16_bf16 v[48:63], v[180:183], a[104:107], v[48:63]
    s_add_u32 s63, s63, 4096
    buffer_load_dwordx4 v[152:155], v3, s[8:11], s63 offen offset:0 sc1
    v_mfma_f32_32x32x16_bf16 v[64:79], v[184:187], a[104:107], v[64:79]
    ds_read_b128 v[16:19], v8 offset:0
    ds_read_b128 v[24:27], v8 offset:8192
    ds_read_b128 v[32:35], v8 offset:16384
    ds_read_b128 v[40:43], v8 offset:24576
    ds_read_b128 v[20:23], v9 offset:0
    s_waitcnt vmcnt(11)
    v_mfma_f32_32x32x16_bf16 v[48:63], v[188:191], a[48:51], v[48:63]
    buffer_load_dwordx4 v[156:159], v3, s[8:11], s63 offen offset:1024 sc1
    v_mfma_f32_32x32x16_bf16 v[64:79], v[192:195], a[48:51], v[64:79]
    ds_read_b128 v[28:31], v9 offset:8192
    ds_read_b128 v[36:39], v9 offset:16384
    ds_read_b128 v[44:47], v9 offset:24576
    v_add_u32 v8, 0xfffe4000, v8
    v_add_u32 v9, 0xfffe4000, v9
    s_waitcnt vmcnt(11)
    v_mfma_f32_32x32x16_bf16 v[48:63], v[196:199], a[108:111], v[48:63]
    buffer_load_dwordx4 v[160:163], v3, s[8:11], s63 offen offset:2048 sc1
    v_mfma_f32_32x32x16_bf16 v[64:79], v[200:203], a[108:111], v[64:79]
    v_add_u32 v10, 0xfffe4000, v10
    v_add_u32 v11, 0xfffe4000, v11
    v_add_u32 v12, 0xfffe4000, v12
    v_add_u32 v13, 0xfffe4000, v13
    s_waitcnt lgkmcnt(4)
    s_waitcnt vmcnt(11)
    v_mfma_f32_32x32x16_bf16 v[48:63], v[204:207], a[112:115], v[48:63]
    buffer_load_dwordx4 v[164:167], v3, s[8:11], s63 offen offset:3072 sc1
    v_mfma_f32_32x32x16_bf16 v[64:79], v[208:211], a[112:115], v[64:79]
    v_add_f32 v16, v16, v24
    v_add_f32 v17, v17, v25
    v_add_f32 v18, v18, v26
    v_add_f32 v19, v19, v27
    v_add_f32 v32, v32, v40
    s_waitcnt vmcnt(11)
    v_mfma_f32_32x32x16_bf16 v[48:63], v[212:215], a[56:59], v[48:63]
    s_add_u32 s63, s63, 4096
    buffer_load_dwordx4 v[168:171], v3, s[8:11], s63 offen offset:0 sc1
    v_mfma_f32_32x32x16_bf16 v[64:79], v[216:219], a[56:59], v[64:79]
    v_add_f32 v33, v33, v41
    v_add_f32 v34, v34, v42
    v_add_f32 v35, v35, v43
    v_add_f32 v16, v16, v32
    v_add_f32 v17, v17, v33
    s_waitcnt vmcnt(11)
    v_mfma_f32_32x32x16_bf16 v[48:63], v[220:223], a[116:119], v[48:63]
    buffer_load_dwordx4 v[172:175], v3, s[8:11], s63 offen offset:1024 sc1
    v_mfma_f32_32x32x16_bf16 v[64:79], v[224:227], a[116:119], v[64:79]
    v_add_f32 v18, v18, v34
    v_add_f32 v19, v19, v35
    v_fma_f32 v16, v16, v88, v104
    v_fma_f32 v17, v17, v89, v105
    v_fma_f32 v18, v18, v90, v106
    s_waitcnt vmcnt(11)
    v_mfma_f32_32x32x16_bf16 v[48:63], v[228:231], a[84:87], v[48:63]
    buffer_load_dwordx4 v[176:179], v3, s[8:11], s63 offen offset:2048 sc1
    v_mfma_f32_32x32x16_bf16 v[64:79], v[232:235], a[84:87], v[64:79]
    v_fma_f32 v19, v19, v91, v107
    v_cvt_pk_bf16_f32 v120, v16, v17
    v_cvt_pk_bf16_f32 v121, v18, v19
    s_waitcnt lgkmcnt(0)
    v_add_f32 v20, v20, v28
    s_waitcnt vmcnt(11)
    v_mfma_f32_32x32x16_bf16 v[48:63], v[236:239], v[132:135], v[48:63]
    buffer_load_dwordx4 v[180:183], v3, s[8:11], s63 offen offset:3072 sc1
    v_mfma_f32_32x32x16_bf16 v[64:79], v[240:243], v[132:135], v[64:79]
    v_add_f32 v21, v21, v29
    v_add_f32 v22, v22, v30
    v_add_f32 v23, v23, v31
    v_add_f32 v36, v36, v44
    v_add_f32 v37, v37, v45
    s_waitcnt vmcnt(11)
    v_mfma_f32_32x32x16_bf16 v[48:63], v[244:247], v[136:139], v[48:63]
    s_add_u32 s63, s63, 4096
    buffer_load_dwordx4 v[132:135], v3, s[8:11], s63 offen offset:0 sc1
    v_mfma_f32_32x32x16_bf16 v[64:79], v[248:251], v[136:139], v[64:79]
    v_add_f32 v38, v38, v46
    v_add_f32 v39, v39, v47
    v_add_f32 v20, v20, v36
    v_add_f32 v21, v21, v37
    v_add_f32 v22, v22, v38
    s_waitcnt vmcnt(11)
    v_mfma_f32_32x32x16_bf16 v[48:63], v[252:255], v[140:143], v[48:63]
    buffer_load_dwordx4 v[136:139], v3, s[8:11], s63 offen offset:1024 sc1
    v_mfma_f32_32x32x16_bf16 v[64:79], a[224:227], v[140:143], v[64:79]
    v_add_f32 v23, v23, v39
    v_fma_f32 v20, v20, v92, v108
    v_fma_f32 v21, v21, v93, v109
    v_fma_f32 v22, v22, v94, v110
    v_fma_f32 v23, v23, v95, v111
    s_waitcnt vmcnt(11)
    v_mfma_f32_32x32x16_bf16 v[48:63], a[228:231], v[144:147], v[48:63]
    v_cvt_pk_bf16_f32 v122, v20, v21
    v_cvt_pk_bf16_f32 v123, v22, v23
    v_mfma_f32_32x32x16_bf16 v[64:79], a[232:235], v[144:147], v[64:79]
    buffer_store_dwordx4 v[120:123], v1, s[16:19], s44 offen sc1
    s_waitcnt vmcnt(11)
    v_mfma_f32_32x32x16_bf16 v[48:63], a[236:239], v[148:151], v[48:63]
    v_mfma_f32_32x32x16_bf16 v[64:79], a[240:243], v[148:151], v[64:79]
    s_waitcnt vmcnt(10)
    v_mfma_f32_32x32x16_bf16 v[48:63], a[244:247], v[152:155], v[48:63]
    v_mfma_f32_32x32x16_bf16 v[64:79], a[248:251], v[152:155], v[64:79]
    s_waitcnt vmcnt(9)
    v_mfma_f32_32x32x16_bf16 v[48:63], a[252:255], v[156:159], v[48:63]
    v_mfma_f32_32x32x16_bf16 v[64:79], a[0:3], v[156:159], v[64:79]
    s_waitcnt vmcnt(8)
    v_mfma_f32_32x32x16_bf16 v[48:63], a[4:7], v[160:163], v[48:63]
    v_mfma_f32_32x32x16_bf16 v[64:79], a[8:11], v[160:163], v[64:79]
    s_waitcnt vmcnt(7)
    v_mfma_f32_32x32x16_bf16 v[48:63], a[12:15], v[164:167], v[48:63]
    v_mfma_f32_32x32x16_bf16 v[64:79], a[16:19], v[164:167], v[64:79]
    s_waitcnt vmcnt(6)
    v_mfma_f32_32x32x16_bf16 v[48:63], a[20:23], v[168:171], v[48:63]
    v_mfma_f32_32x32x16_bf16 v[64:79], a[60:63], v[168:171], v[64:79]
    s_waitcnt vmcnt(5)
    v_mfma_f32_32x32x16_bf16 v[48:63], a[68:71], v[172:175], v[48:63]
    v_mfma_f32_32x32x16_bf16 v[64:79], a[72:75], v[172:175], v[64:79]
    s_waitcnt vmcnt(4)
    v_mfma_f32_32x32x16_bf16 v[48:63], a[28:31], v[176:179], v[48:63]
    v_mfma_f32_32x32x16_bf16 v[64:79], a[32:35], v[176:179], v[64:79]
    s_waitcnt vmcnt(3)
    v_mfma_f32_32x32x16_bf16 v[48:63], a[40:43], v[180:183], v[48:63]
    v_mfma_f32_32x32x16_bf16 v[64:79], a[44:47], v[180:183], v[64:79]
    s_waitcnt vmcnt(2)
    v_mfma_f32_32x32x16_bf16 v[48:63], a[52:55], v[132:135], v[48:63]
    v_mfma_f32_32x32x16_bf16 v[64:79], a[76:79], v[132:135], v[64:79]
    s_waitcnt vmcnt(1)
    v_mfma_f32_32x32x16_bf16 v[48:63], a[80:83], v[136:139], v[48:63]
    v_mfma_f32_32x32x16_bf16 v[64:79], a[64:67], v[136:139], v[64:79]
    s_nop 10
    ds_write_b128 v10, v[48:51] offset:0
    ds_write_b128 v11, v[52:55] offset:0
    ds_write_b128 v12, v[56:59] offset:0
    ds_write_b128 v13, v[60:63] offset:0
    ds_write_b128 v10, v[64:67] offset:128
    ds_write_b128 v11, v[68:71] offset:128
    ds_write_b128 v12, v[72:75] offset:128
    ds_write_b128 v13, v[76:79] offset:128
    s_waitcnt lgkmcnt(0)
    s_barrier
    ds_read_b128 v[48:51], v8 offset:0
    ds_read_b128 v[56:59], v8 offset:8192
    ds_read_b128 v[64:67], v8 offset:16384
    ds_read_b128 v[72:75], v8 offset:24576
    ds_read_b128 v[52:55], v9 offset:0
    ds_read_b128 v[60:63], v9 offset:8192
    ds_read_b128 v[68:71], v9 offset:16384
    ds_read_b128 v[76:79], v9 offset:24576
    s_waitcnt lgkmcnt(4)
    v_pk_add_f32 v[48:49], v[48:49], v[56:57]
    v_pk_add_f32 v[50:51], v[50:51], v[58:59]
    v_pk_add_f32 v[64:65], v[64:65], v[72:73]
    v_pk_add_f32 v[66:67], v[66:67], v[74:75]
    v_pk_add_f32 v[48:49], v[48:49], v[64:65]
    v_pk_add_f32 v[50:51], v[50:51], v[66:67]
    v_pk_fma_f32 v[48:49], v[48:49], v[96:97], v[112:113]
    v_pk_fma_f32 v[50:51], v[50:51], v[98:99], v[114:115]
    v_cvt_pk_bf16_f32 v124, v48, v49
    v_cvt_pk_bf16_f32 v125, v50, v51
    s_waitcnt lgkmcnt(0)
    v_pk_add_f32 v[52:53], v[52:53], v[60:61]
    v_pk_add_f32 v[54:55], v[54:55], v[62:63]
    v_pk_add_f32 v[68:69], v[68:69], v[76:77]
    v_pk_add_f32 v[70:71], v[70:71], v[78:79]
    v_pk_add_f32 v[52:53], v[52:53], v[68:69]
    v_pk_add_f32 v[54:55], v[54:55], v[70:71]
    v_pk_fma_f32 v[52:53], v[52:53], v[100:101], v[116:117]
    v_pk_fma_f32 v[54:55], v[54:55], v[102:103], v[118:119]
    v_cvt_pk_bf16_f32 v126, v52, v53
    v_cvt_pk_bf16_f32 v127, v54, v55
    buffer_store_dwordx4 v[124:127], v1, s[16:19], s45 offen sc1
k_fin:
k_end:
    s_endpgm
k_spare2:
    s_lshr_b32 s27, s24, 2
    s_lshl_b32 s27, s27, 3
    s_bfe_u32 s28, s24, 0x10001
    s_and_b32 s3, s24, 1
    s_lshl2_add_u32 s3, s3, s25
    s_add_u32 s27, s27, s3
    v_lshrrev_b32 v4, 5, v2
    v_bfe_u32 v5, v2, 2, 2
    v_and_b32 v6, 3, v2
    v_lshlrev_b32 v6, 3, v6
    v_lshl_add_u32 v6, v5, 6, v6
    v_bfe_u32 v5, v2, 4, 1
    v_lshl_add_u32 v6, v5, 5, v6
    v_lshl_add_u32 v12, v4, 9, v6
    v_and_b32 v1, 31, v2
    s_mov_b32 s32, 0x3f803f80
    v_mov_b32 v72, 0
    v_mov_b32 v73, 0
    v_mov_b32 v74, 0
    v_mov_b32 v75, 0
    v_and_b32 v9, 1, v2
    v_lshlrev_b32 v9, 1, v9
    v_lshrrev_b32 v14, 2, v8
    v_add_u32 v9, v9, v14
    v_bfe_u32 v14, v2, 1, 1
    v_lshl_add_u32 v9, v9, 3, v14
    s_lshl_b32 s3, s23, 1
    v_add_u32 v9, s3, v9
    v_and_b32 v14, 3, v8
    v_lshl_add_u32 v9, v9, 2, v14
    v_lshlrev_b32 v9, 2, v9
    v_add_u32 v9, 117760, v9
    s_lshl_b32 s3, s4, 9
    s_add_u32 s76, s3, 6291456
    s_lshl_b32 s3, s4, 7
    s_add_u32 s30, s3, 6815744
    s_and_b32 s3, s24, 3
    s_lshr_b32 s7, s24, 2
    s_lshl2_add_u32 s7, s7, s25
    s_cmp_lt_u32 s7, 7
    s_cselect_b32 s21, 7, 1
    s_cselect_b32 s22, 0, 21
    s_mul_i32 s3, s3, s21
    s_add_u32 s7, s7, s3
    s_add_u32 s7, s7, s22
    s_lshl2_add_u32 s33, s7, s23
    s_and_b32 s37, s33, 1
    v_bfe_u32 v13, v2, 4, 1
    v_and_b32 v77, 3, v2
    s_and_b32 s3, s23, 2
    v_or_b32 v14, s3, v13
    v_lshlrev_b32 v14, 1, v14
    v_xor_b32 v14, v14, v10
    v_mul_u32_u24 v79, 3584, v8
    v_lshl_add_u32 v79, v14, 4, v79
    s_and_b32 s3, s23, 1
    s_lshl_b32 s43, s3, 10
    s_mul_i32 s42, s3, 28672
    s_lshl_b32 s3, s7, 7
    s_add_u32 s42, s42, s3
    s_lshr_b32 s3, s23, 1
    s_mul_i32 s3, s3, 57344
    s_add_u32 s43, s43, s3
    s_cmp_ge_u32 s23, 2
    s_cselect_b32 s12, s52, s50
    s_cselect_b32 s13, s53, s51
    s_cmp_lt_u32 s7, 28
    s_cselect_b32 s14, 1605632, 0
    s_mov_b32 s15, 0x20000
    s_waitcnt vmcnt(7)
    v_dot2c_f32_bf16 v72, s32, v16
    v_dot2c_f32_bf16 v73, v16, v16
    s_add_u32 m0, s43, 0
    s_nop 0
    buffer_load_dwordx4 v79, s[12:15], s42 offen lds
    v_dot2c_f32_bf16 v72, s32, v17
    v_dot2c_f32_bf16 v73, v17, v17
    v_dot2c_f32_bf16 v72, s32, v18
    v_dot2c_f32_bf16 v73, v18, v18
    v_dot2c_f32_bf16 v72, s32, v19
    v_dot2c_f32_bf16 v73, v19, v19
    v_dot2c_f32_bf16 v72, s32, v20
    v_dot2c_f32_bf16 v73, v20, v20
    v_dot2c_f32_bf16 v72, s32, v21
    v_dot2c_f32_bf16 v73, v21, v21
    s_add_u32 m0, s43, 2048
    s_add_u32 s42, s42, 57344
    buffer_load_dwordx4 v79, s[12:15], s42 offen lds
    v_dot2c_f32_bf16 v72, s32, v22
    v_dot2c_f32_bf16 v73, v22, v22
    v_dot2c_f32_bf16 v72, s32, v23
    v_dot2c_f32_bf16 v73, v23, v23
    v_dot2c_f32_bf16 v72, s32, v24
    v_dot2c_f32_bf16 v73, v24, v24
    v_dot2c_f32_bf16 v72, s32, v25
    v_dot2c_f32_bf16 v73, v25, v25
    v_dot2c_f32_bf16 v72, s32, v26
    v_dot2c_f32_bf16 v73, v26, v26
    s_add_u32 m0, s43, 4096
    s_add_u32 s42, s42, 57344
    buffer_load_dwordx4 v79, s[12:15], s42 offen lds
    v_dot2c_f32_bf16 v72, s32, v27
    v_dot2c_f32_bf16 v73, v27, v27
    v_dot2c_f32_bf16 v72, s32, v28
    v_dot2c_f32_bf16 v73, v28, v28
    v_dot2c_f32_bf16 v72, s32, v29
    v_dot2c_f32_bf16 v73, v29, v29
    v_dot2c_f32_bf16 v72, s32, v30
    v_dot2c_f32_bf16 v73, v30, v30
    v_dot2c_f32_bf16 v72, s32, v31
    v_dot2c_f32_bf16 v73, v31, v31
    v_dot2c_f32_bf16 v72, s32, v32
    v_dot2c_f32_bf16 v73, v32, v32
    v_dot2c_f32_bf16 v72, s32, v33
    v_dot2c_f32_bf16 v73, v33, v33
    v_dot2c_f32_bf16 v72, s32, v34
    v_dot2c_f32_bf16 v73, v34, v34
    v_dot2c_f32_bf16 v72, s32, v35
    v_dot2c_f32_bf16 v73, v35, v35
    v_dot2c_f32_bf16 v72, s32, v36
    v_dot2c_f32_bf16 v73, v36, v36
    v_dot2c_f32_bf16 v72, s32, v37
    v_dot2c_f32_bf16 v73, v37, v37
    v_dot2c_f32_bf16 v72, s32, v38
    v_dot2c_f32_bf16 v73, v38, v38
    v_dot2c_f32_bf16 v72, s32, v39
    v_dot2c_f32_bf16 v73, v39, v39
    v_dot2c_f32_bf16 v72, s32, v40
    v_dot2c_f32_bf16 v73, v40, v40
    v_dot2c_f32_bf16 v72, s32, v41
    v_dot2c_f32_bf16 v73, v41, v41
    v_dot2c_f32_bf16 v72, s32, v42
    v_dot2c_f32_bf16 v73, v42, v42
    v_dot2c_f32_bf16 v72, s32, v43
    v_dot2c_f32_bf16 v73, v43, v43
    s_waitcnt vmcnt(3)
    v_dot2c_f32_bf16 v74, s32, v44
    v_dot2c_f32_bf16 v75, v44, v44
    v_dot2c_f32_bf16 v74, s32, v45
    v_dot2c_f32_bf16 v75, v45, v45
    v_dot2c_f32_bf16 v74, s32, v46
    v_dot2c_f32_bf16 v75, v46, v46
    v_dot2c_f32_bf16 v74, s32, v47
    v_dot2c_f32_bf16 v75, v47, v47
    v_dot2c_f32_bf16 v74, s32, v48
    v_dot2c_f32_bf16 v75, v48, v48
    v_dot2c_f32_bf16 v74, s32, v49
    v_dot2c_f32_bf16 v75, v49, v49
    v_dot2c_f32_bf16 v74, s32, v50
    v_dot2c_f32_bf16 v75, v50, v50
    v_dot2c_f32_bf16 v74, s32, v51
    v_dot2c_f32_bf16 v75, v51, v51
    v_dot2c_f32_bf16 v74, s32, v52
    v_dot2c_f32_bf16 v75, v52, v52
    v_dot2c_f32_bf16 v74, s32, v53
    v_dot2c_f32_bf16 v75, v53, v53
    v_dot2c_f32_bf16 v74, s32, v54
    v_dot2c_f32_bf16 v75, v54, v54
    v_dot2c_f32_bf16 v74, s32, v55
    v_dot2c_f32_bf16 v75, v55, v55
    v_dot2c_f32_bf16 v74, s32, v56
    v_dot2c_f32_bf16 v75, v56, v56
    v_dot2c_f32_bf16 v74, s32, v57
    v_dot2c_f32_bf16 v75, v57, v57
    v_dot2c_f32_bf16 v74, s32, v58
    v_dot2c_f32_bf16 v75, v58, v58
    v_dot2c_f32_bf16 v74, s32, v59
    v_dot2c_f32_bf16 v75, v59, v59
    v_dot2c_f32_bf16 v74, s32, v60
    v_dot2c_f32_bf16 v75, v60, v60
    v_dot2c_f32_bf16 v74, s32, v61
    v_dot2c_f32_bf16 v75, v61, v61
    v_dot2c_f32_bf16 v74, s32, v62
    v_dot2c_f32_bf16 v75, v62, v62
    v_dot2c_f32_bf16 v74, s32, v63
    v_dot2c_f32_bf16 v75, v63, v63
    v_dot2c_f32_bf16 v74, s32, v64
    v_dot2c_f32_bf16 v75, v64, v64
    v_dot2c_f32_bf16 v74, s32, v65
    v_dot2c_f32_bf16 v75, v65, v65
    v_dot2c_f32_bf16 v74, s32, v66
    v_dot2c_f32_bf16 v75, v66, v66
    v_dot2c_f32_bf16 v74, s32, v67
    v_dot2c_f32_bf16 v75, v67, v67
    v_dot2c_f32_bf16 v74, s32, v68
    v_dot2c_f32_bf16 v75, v68, v68
    v_dot2c_f32_bf16 v74, s32, v69
    v_dot2c_f32_bf16 v75, v69, v69
    v_dot2c_f32_bf16 v74, s32, v70
    v_dot2c_f32_bf16 v75, v70, v70
    v_dot2c_f32_bf16 v74, s32, v71
    v_dot2c_f32_bf16 v75, v71, v71
    v_and_b32 v76, 1, v2
    v_cmp_eq_u32 vcc, 0, v76
    v_and_b32 v76, 2, v2
    v_cmp_eq_u32 s[78:79], 0, v76
    s_nop 0
    v_add_f32_dpp v72, v72, v72 quad_perm:[1,0,3,2] row_mask:0xf bank_mask:0xf
    v_add_f32_dpp v73, v73, v73 quad_perm:[1,0,3,2] row_mask:0xf bank_mask:0xf
    s_nop 0
    v_add_f32_dpp v72, v72, v72 quad_perm:[2,3,0,1] row_mask:0xf bank_mask:0xf
    v_add_f32_dpp v73, v73, v73 quad_perm:[2,3,0,1] row_mask:0xf bank_mask:0xf
    s_nop 0
    v_add_f32_dpp v72, v72, v72 row_half_mirror row_mask:0xf bank_mask:0xf
    v_add_f32_dpp v73, v73, v73 row_half_mirror row_mask:0xf bank_mask:0xf
    v_mul_f32 v72, 0x3b124925, v72
    v_mul_f32 v73, 0x3b124925, v73
    v_fma_f32 v73, -v72, v72, v73
    v_max_f32 v73, 0, v73
    v_cvt_pk_bf16_f32 v76, v72, v73
    v_and_b32 v73, 0xffff0000, v76
    v_add_f32 v73, 0x3727c5ac, v73
    v_cvt_pk_bf16_f32 v73, v73, v73
    v_lshlrev_b32 v73, 16, v73
    v_sqrt_f32 v73, v73
    v_lshlrev_b32 v72, 16, v76
    v_cvt_pk_bf16_f32 v73, v73, v73
    v_lshlrev_b32 v73, 16, v73
    v_rcp_f32 v73, v73
    s_nop 0
    v_mul_f32 v72, -v72, v73
    v_cndmask_b32 v72, v72, v73, vcc
    s_nop 0
    v_add_f32_dpp v74, v74, v74 quad_perm:[1,0,3,2] row_mask:0xf bank_mask:0xf
    v_add_f32_dpp v75, v75, v75 quad_perm:[1,0,3,2] row_mask:0xf bank_mask:0xf
    s_nop 0
    v_add_f32_dpp v74, v74, v74 quad_perm:[2,3,0,1] row_mask:0xf bank_mask:0xf
    v_add_f32_dpp v75, v75, v75 quad_perm:[2,3,0,1] row_mask:0xf bank_mask:0xf
    s_nop 0
    v_add_f32_dpp v74, v74, v74 row_half_mirror row_mask:0xf bank_mask:0xf
    v_add_f32_dpp v75, v75, v75 row_half_mirror row_mask:0xf bank_mask:0xf
    v_mul_f32 v74, 0x3b124925, v74
    v_mul_f32 v75, 0x3b124925, v75
    v_fma_f32 v75, -v74, v74, v75
    v_max_f32 v75, 0, v75
    v_cvt_pk_bf16_f32 v76, v74, v75
    v_and_b32 v75, 0xffff0000, v76
    v_add_f32 v75, 0x3727c5ac, v75
    v_cvt_pk_bf16_f32 v75, v75, v75
    v_lshlrev_b32 v75, 16, v75
    v_sqrt_f32 v75, v75
    v_lshlrev_b32 v74, 16, v76
    v_cvt_pk_bf16_f32 v75, v75, v75
    v_lshlrev_b32 v75, 16, v75
    v_rcp_f32 v75, v75
    s_nop 0
    v_mul_f32 v74, -v74, v75
    v_cndmask_b32 v74, v74, v75, vcc
    v_cndmask_b32 v72, v74, v72, s[78:79]
    ds_write_b32 v9, v72
    v_readfirstlane_b32 s5, v78
    s_nop 0
    s_add_u32 s5, s5, 0x9e3779b8
    s_or_b32 s5, s5, 1
    v_and_b32 v131, 32, v2
    v_lshlrev_b32 v131, 25, v131
    v_lshl_add_u32 v131, v2, 2, v131
    s_lshl_b32 s3, s23, 28
    v_or_b32 v131, s3, v131
    v_lshlrev_b32 v73, 3, v2
    v_add_u32 v74, 117760, v73
    v_or_b32 v73, s3, v73
    s_waitcnt lgkmcnt(0)
    s_barrier
    ds_read_b64 v[74:75], v74
    s_waitcnt lgkmcnt(0)
    buffer_store_dwordx2 v[74:75], v73, s[8:11], s76 offen sc1
    s_add_u32 m0, s43, 6144
    s_add_u32 s42, s42, 57344
    buffer_load_dwordx4 v79, s[12:15], s42 offen lds
    s_add_u32 m0, s43, 8192
    s_add_u32 s42, s42, 57344
    buffer_load_dwordx4 v79, s[12:15], s42 offen lds
    s_add_u32 m0, s43, 10240
    s_add_u32 s42, s42, 57344
    buffer_load_dwordx4 v79, s[12:15], s42 offen lds
    s_add_u32 m0, s43, 12288
    s_add_u32 s42, s42, 57344
    buffer_load_dwordx4 v79, s[12:15], s42 offen lds
    s_add_u32 m0, s43, 14336
    s_add_u32 s42, s42, 57344
    buffer_load_dwordx4 v79, s[12:15], s42 offen lds
    s_waitcnt vmcnt(5)
    v_mov_b32 v76, s5
    buffer_store_dword v76, v131, s[8:11], s30 offen sc1
    s_barrier
    s_cmp_ge_u32 s7, 28
    s_cbranch_scc1 k_tab
    s_mov_b32 s72, s54
    s_mov_b32 s73, s55
    s_mov_b32 s74, 0x188000
    s_mov_b32 s75, 0x20000
    s_mul_i32 s38, s33, 14336
    v_min_u32 v85, 55, v2
    v_lshlrev_b32 v85, 7, v85
    s_add_u32 s39, s38, 7168
    s_add_u32 m0, s43, 16384
    s_add_u32 s42, s42, 57344
    buffer_load_dwordx4 v79, s[12:15], s42 offen lds
    s_add_u32 m0, s43, 18432
    s_add_u32 s42, s42, 57344
    buffer_load_dwordx4 v79, s[12:15], s42 offen lds
    s_add_u32 m0, s43, 20480
    s_add_u32 s42, s42, 57344
    buffer_load_dwordx4 v79, s[12:15], s42 offen lds
    s_add_u32 m0, s43, 22528
    s_add_u32 s42, s42, 57344
    buffer_load_dwordx4 v79, s[12:15], s42 offen lds
    s_add_u32 m0, s43, 24576
    s_add_u32 s42, s42, 57344
    buffer_load_dwordx4 v79, s[12:15], s42 offen lds
    s_add_u32 m0, s43, 26624
    s_add_u32 s42, s42, 57344
    buffer_load_dwordx4 v79, s[12:15], s42 offen lds
    s_add_u32 m0, s43, 28672
    s_add_u32 s42, s42, 57344
    buffer_load_dwordx4 v79, s[12:15], s42 offen lds
    s_add_u32 m0, s43, 30720
    s_add_u32 s42, s42, 57344
    buffer_load_dwordx4 v79, s[12:15], s42 offen lds
    s_add_u32 m0, s43, 32768
    s_add_u32 s42, s42, 57344
    buffer_load_dwordx4 v79, s[12:15], s42 offen lds
    s_add_u32 m0, s43, 34816
    s_add_u32 s42, s42, 57344
    buffer_load_dwordx4 v79, s[12:15], s42 offen lds
    s_add_u32 m0, s43, 36864
    s_add_u32 s42, s42, 57344
    buffer_load_dwordx4 v79, s[12:15], s42 offen lds
    s_add_u32 m0, s43, 38912
    s_add_u32 s42, s42, 57344
    buffer_load_dwordx4 v79, s[12:15], s42 offen lds
    s_add_u32 m0, s43, 40960
    s_add_u32 s42, s42, 57344
    buffer_load_dwordx4 v79, s[12:15], s42 offen lds
    s_add_u32 m0, s43, 43008
    s_add_u32 s42, s42, 57344
    buffer_load_dwordx4 v79, s[12:15], s42 offen lds
    s_add_u32 m0, s43, 45056
    s_add_u32 s42, s42, 57344
    buffer_load_dwordx4 v79, s[12:15], s42 offen lds
    s_add_u32 m0, s43, 47104
    s_add_u32 s42, s42, 57344
    buffer_load_dwordx4 v79, s[12:15], s42 offen lds
    s_add_u32 m0, s43, 49152
    s_add_u32 s42, s42, 57344
    buffer_load_dwordx4 v79, s[12:15], s42 offen lds
    s_add_u32 m0, s43, 51200
    s_add_u32 s42, s42, 57344
    buffer_load_dwordx4 v79, s[12:15], s42 offen lds
    s_add_u32 m0, s43, 53248
    s_add_u32 s42, s42, 57344
    buffer_load_dwordx4 v79, s[12:15], s42 offen lds
    s_add_u32 m0, s43, 55296
    s_add_u32 s42, s42, 57344
    buffer_load_dwordx4 v79, s[12:15], s42 offen lds
    v_min_u32 v80, 223, v0
    v_lshlrev_b32 v81, 2, v80
    v_add_u32 v81, 114688, v81
    v_lshlrev_b32 v80, 4, v80
    s_mov_b32 s44, 6324224
    buffer_load_dwordx4 v[136:139], v80, s[8:11], s44 offen sc1
    buffer_load_dword v86, v85, s[72:75], s38 offen
    buffer_load_dword v86, v85, s[72:75], s39 offen
    s_waitcnt vmcnt(2)
    v_cmp_ne_u32 vcc, s5, v139
    s_nop 4
    s_cbranch_vccnz k_slow_uv
k_uv_go:
    ds_write2_b32 v81, v138, v137 offset0:0 offset1:224
    v_and_b32 v82, 1, v2
    v_xor_b32 v82, 1, v82
    v_mul_u32_u24 v82, 896, v82
    v_lshl_add_u32 v82, v4, 4, v82
    v_add_u32 v82, 114688, v82
    v_bfe_u32 v83, v2, 2, 2
    v_lshl_add_u32 v83, v4, 3, v83
    v_lshlrev_b32 v83, 7, v83
    v_lshl_add_u32 v83, v77, 3, v83
    v_bfe_u32 v84, v2, 3, 2
    v_xor_b32 v84, s23, v84
    v_lshl_add_u32 v83, v84, 5, v83
    v_mul_u32_u24 v84, 57344, v13
    v_add_u32 v83, v83, v84
    s_lshr_b32 s34, s7, 1
    s_cmp_ge_u32 s34, 7
    s_cselect_b32 s35, 21, 0
    s_add_u32 s34, s34, s35
    s_bfe_u32 s35, s33, 0x20001
    s_mul_i32 s35, s35, 7
    s_add_u32 s34, s34, s35
    s_lshl1_add_u32 s34, s34, s37
    s_lshl_b32 s34, s34, 9
    s_add_u32 s34, s34, 6488064
    v_lshl_add_u32 v11, v4, 30, v3
    s_waitcnt lgkmcnt(0)
    s_barrier
    ds_read_b128 v[160:163], v82 offset:0
    ds_read_b64_tr_b16 v[16:17], v83 offset:0
    ds_read_b64_tr_b16 v[18:19], v83 offset:512
    ds_read_b128 v[164:167], v82 offset:32
    ds_read_b64_tr_b16 v[20:21], v83 offset:2048
    ds_read_b64_tr_b16 v[22:23], v83 offset:2560
    ds_read_b128 v[168:171], v82 offset:64
    ds_read_b64_tr_b16 v[24:25], v83 offset:4096
    ds_read_b64_tr_b16 v[26:27], v83 offset:4608
    ds_read_b128 v[172:175], v82 offset:96
    ds_read_b64_tr_b16 v[28:29], v83 offset:6144
    ds_read_b64_tr_b16 v[30:31], v83 offset:6656
    s_waitcnt lgkmcnt(9)
    v_mfma_f32_32x32x16_bf16 v[136:151], v[160:163], v[16:19], 0
    ds_read_b128 v[176:179], v82 offset:128
    ds_read_b64_tr_b16 v[32:33], v83 offset:8192
    ds_read_b64_tr_b16 v[34:35], v83 offset:8704
    s_waitcnt lgkmcnt(9)
    v_mfma_f32_32x32x16_bf16 v[136:151], v[164:167], v[20:23], v[136:151]
    ds_read_b128 v[180:183], v82 offset:160
    ds_read_b64_tr_b16 v[36:37], v83 offset:10240
    ds_read_b64_tr_b16 v[38:39], v83 offset:10752
    s_waitcnt lgkmcnt(9)
    v_mfma_f32_32x32x16_bf16 v[136:151], v[168:171], v[24:27], v[136:151]
    ds_read_b128 v[160:163], v82 offset:192
    ds_read_b64_tr_b16 v[16:17], v83 offset:12288
    ds_read_b64_tr_b16 v[18:19], v83 offset:12800
    s_waitcnt lgkmcnt(9)
    v_mfma_f32_32x32x16_bf16 v[136:151], v[172:175], v[28:31], v[136:151]
    ds_read_b128 v[164:167], v82 offset:224
    ds_read_b64_tr_b16 v[20:21], v83 offset:14336
    ds_read_b64_tr_b16 v[22:23], v83 offset:14848
    s_waitcnt lgkmcnt(9)
    v_mfma_f32_32x32x16_bf16 v[136:151], v[176:179], v[32:35], v[136:151]
    ds_read_b128 v[168:171], v82 offset:256
    ds_read_b64_tr_b16 v[24:25], v83 offset:16384
    ds_read_b64_tr_b16 v[26:27], v83 offset:16896
    s_waitcnt lgkmcnt(9)
    v_mfma_f32_32x32x16_bf16 v[136:151], v[180:183], v[36:39], v[136:151]
    ds_read_b128 v[172:175], v82 offset:288
    ds_read_b64_tr_b16 v[28:29], v83 offset:18432
    ds_read_b64_tr_b16 v[30:31], v83 offset:18944
    s_waitcnt lgkmcnt(9)
    v_mfma_f32_32x32x16_bf16 v[136:151], v[160:163], v[16:19], v[136:151]
    ds_read_b128 v[176:179], v82 offset:320
    ds_read_b64_tr_b16 v[32:33], v83 offset:20480
    ds_read_b64_tr_b16 v[34:35], v83 offset:20992
    s_waitcnt lgkmcnt(9)
    v_mfma_f32_32x32x16_bf16 v[136:151], v[164:167], v[20:23], v[136:151]
    ds_read_b128 v[180:183], v82 offset:352
    ds_read_b64_tr_b16 v[36:37], v83 offset:22528
    ds_read_b64_tr_b16 v[38:39], v83 offset:23040
    s_waitcnt lgkmcnt(9)
    v_mfma_f32_32x32x16_bf16 v[136:151], v[168:171], v[24:27], v[136:151]
    ds_read_b128 v[160:163], v82 offset:384
    ds_read_b64_tr_b16 v[16:17], v83 offset:24576
    ds_read_b64_tr_b16 v[18:19], v83 offset:25088
    s_waitcnt lgkmcnt(9)
    v_mfma_f32_32x32x16_bf16 v[136:151], v[172:175], v[28:31], v[136:151]
    ds_read_b128 v[164:167], v82 offset:416
    ds_read_b64_tr_b16 v[20:21], v83 offset:26624
    ds_read_b64_tr_b16 v[22:23], v83 offset:27136
    s_waitcnt lgkmcnt(9)
    v_mfma_f32_32x32x16_bf16 v[136:151], v[176:179], v[32:35], v[136:151]
    ds_read_b128 v[168:171], v82 offset:448
    ds_read_b64_tr_b16 v[24:25], v83 offset:28672
    ds_read_b64_tr_b16 v[26:27], v83 offset:29184
    s_waitcnt lgkmcnt(9)
    v_mfma_f32_32x32x16_bf16 v[136:151], v[180:183], v[36:39], v[136:151]
    ds_read_b128 v[172:175], v82 offset:480
    ds_read_b64_tr_b16 v[28:29], v83 offset:30720
    ds_read_b64_tr_b16 v[30:31], v83 offset:31232
    s_waitcnt lgkmcnt(9)
    v_mfma_f32_32x32x16_bf16 v[136:151], v[160:163], v[16:19], v[136:151]
    ds_read_b128 v[176:179], v82 offset:512
    ds_read_b64_tr_b16 v[32:33], v83 offset:32768
    ds_read_b64_tr_b16 v[34:35], v83 offset:33280
    s_waitcnt lgkmcnt(9)
    v_mfma_f32_32x32x16_bf16 v[136:151], v[164:167], v[20:23], v[136:151]
    ds_read_b128 v[180:183], v82 offset:544
    ds_read_b64_tr_b16 v[36:37], v83 offset:34816
    ds_read_b64_tr_b16 v[38:39], v83 offset:35328
    s_waitcnt lgkmcnt(9)
    v_mfma_f32_32x32x16_bf16 v[136:151], v[168:171], v[24:27], v[136:151]
    ds_read_b128 v[160:163], v82 offset:576
    ds_read_b64_tr_b16 v[16:17], v83 offset:36864
    ds_read_b64_tr_b16 v[18:19], v83 offset:37376
    s_waitcnt lgkmcnt(9)
    v_mfma_f32_32x32x16_bf16 v[136:151], v[172:175], v[28:31], v[136:151]
    ds_read_b128 v[164:167], v82 offset:608
    ds_read_b64_tr_b16 v[20:21], v83 offset:38912
    ds_read_b64_tr_b16 v[22:23], v83 offset:39424
    s_waitcnt lgkmcnt(9)
    v_mfma_f32_32x32x16_bf16 v[136:151], v[176:179], v[32:35], v[136:151]
    ds_read_b128 v[168:171], v82 offset:640
    ds_read_b64_tr_b16 v[24:25], v83 offset:40960
    ds_read_b64_tr_b16 v[26:27], v83 offset:41472
    s_waitcnt lgkmcnt(9)
    v_mfma_f32_32x32x16_bf16 v[136:151], v[180:183], v[36:39], v[136:151]
    ds_read_b128 v[172:175], v82 offset:672
    ds_read_b64_tr_b16 v[28:29], v83 offset:43008
    ds_read_b64_tr_b16 v[30:31], v83 offset:43520
    s_waitcnt lgkmcnt(9)
    v_mfma_f32_32x32x16_bf16 v[136:151], v[160:163], v[16:19], v[136:151]
    ds_read_b128 v[176:179], v82 offset:704
    ds_read_b64_tr_b16 v[32:33], v83 offset:45056
    ds_read_b64_tr_b16 v[34:35], v83 offset:45568
    s_waitcnt lgkmcnt(9)
    v_mfma_f32_32x32x16_bf16 v[136:151], v[164:167], v[20:23], v[136:151]
    ds_read_b128 v[180:183], v82 offset:736
    ds_read_b64_tr_b16 v[36:37], v83 offset:47104
    ds_read_b64_tr_b16 v[38:39], v83 offset:47616
    s_waitcnt lgkmcnt(9)
    v_mfma_f32_32x32x16_bf16 v[136:151], v[168:171], v[24:27], v[136:151]
    ds_read_b128 v[160:163], v82 offset:768
    ds_read_b64_tr_b16 v[16:17], v83 offset:49152
    ds_read_b64_tr_b16 v[18:19], v83 offset:49664
    s_waitcnt lgkmcnt(9)
    v_mfma_f32_32x32x16_bf16 v[136:151], v[172:175], v[28:31], v[136:151]
    ds_read_b128 v[164:167], v82 offset:800
    ds_read_b64_tr_b16 v[20:21], v83 offset:51200
    ds_read_b64_tr_b16 v[22:23], v83 offset:51712
    s_waitcnt lgkmcnt(9)
    v_mfma_f32_32x32x16_bf16 v[136:151], v[176:179], v[32:35], v[136:151]
    ds_read_b128 v[168:171], v82 offset:832
    ds_read_b64_tr_b16 v[24:25], v83 offset:53248
    ds_read_b64_tr_b16 v[26:27], v83 offset:53760
    s_waitcnt lgkmcnt(9)
    v_mfma_f32_32x32x16_bf16 v[136:151], v[180:183], v[36:39], v[136:151]
    ds_read_b128 v[172:175], v82 offset:864
    ds_read_b64_tr_b16 v[28:29], v83 offset:55296
    ds_read_b64_tr_b16 v[30:31], v83 offset:55808
    s_waitcnt lgkmcnt(9)
    v_mfma_f32_32x32x16_bf16 v[136:151], v[160:163], v[16:19], v[136:151]
    s_waitcnt lgkmcnt(6)
    v_mfma_f32_32x32x16_bf16 v[136:151], v[164:167], v[20:23], v[136:151]
    s_waitcnt lgkmcnt(3)
    v_mfma_f32_32x32x16_bf16 v[136:151], v[168:171], v[24:27], v[136:151]
    s_waitcnt lgkmcnt(0)
    v_mfma_f32_32x32x16_bf16 v[136:151], v[172:175], v[28:31], v[136:151]
    v_mov_b32 v90, s5
    v_mov_b32 v91, s5
    s_nop 9
    v_cvt_pk_bf16_f32 v88, v136, v137
    v_lshlrev_b32 v92, 16, v88
    v_and_b32 v93, 0xffff0000, v88
    v_sub_f32 v88, v136, v92
    v_sub_f32 v89, v137, v93
    v_cvt_pk_bf16_f32 v88, v92, v88
    v_cvt_pk_bf16_f32 v89, v93, v89
    buffer_store_dwordx4 v[88:91], v11, s[8:11], s34 offen sc1
k_stat:
    s_and_b32 s3, s27, 12
    s_add_u32 s3, s3, s23
    s_mul_i32 s3, s3, 7168
    s_add_u32 s3, s3, 6684672
    v_min_u32 v127, 55, v2
    v_lshl_add_u32 v127, v127, 7, s3
    s_lshl1_add_u32 s27, s27, s28
    s_mul_i32 s30, s27, 28672
    s_mul_i32 s3, s23, 7168
    s_add_u32 s30, s30, s3
    s_add_u32 s30, s30, 4194304
    s_lshl_b32 s31, s23, 14
    v_add_u32 v8, s31, v12
    v_lshlrev_b32 v9, 2, v0
    v_add_u32 v9, 114688, v9
    v_lshlrev_b32 v10, 2, v2
    v_add_u32 v10, 114688, v10
    s_lshl_b32 s33, s27, 8
    s_add_u32 s33, s33, 6422528
    v_lshrrev_b32 v4, 5, v0
    v_lshlrev_b32 v7, 3, v1
    v_lshl_add_u32 v7, v4, 28, v7
    s_mov_b32 s22, 400000
k_s2_spin:
    buffer_load_dword v12, v127, s[8:11], 0 offen sc1
    s_waitcnt vmcnt(0)
    v_cmp_ne_u32 vcc, s5, v12
    s_nop 4
    s_cbranch_vccz k_s2_go
    s_sub_u32 s22, s22, 1
    s_cmp_lg_u32 s22, 0
    s_cbranch_scc1 k_s2_spin
k_s2_go:
    s_barrier
    s_add_u32 m0, s31, 0
    s_nop 0
    buffer_load_dwordx4 v3, s[8:11], s30 offen offset:0 sc1 lds
    buffer_load_dwordx4 v3, s[8:11], s30 offen offset:1024 sc1 lds
    buffer_load_dwordx4 v3, s[8:11], s30 offen offset:2048 sc1 lds
    buffer_load_dwordx4 v3, s[8:11], s30 offen offset:3072 sc1 lds
    s_add_u32 m0, s31, 4096
    s_add_u32 s30, s30, 4096
    buffer_load_dwordx4 v3, s[8:11], s30 offen offset:0 sc1 lds
    buffer_load_dwordx4 v3, s[8:11], s30 offen offset:1024 sc1 lds
    buffer_load_dwordx4 v3, s[8:11], s30 offen offset:2048 sc1 lds
    v_mov_b32 v12, 0
    v_mov_b32 v13, 0
    s_waitcnt vmcnt(6)
    ds_read_b64_tr_b16 v[16:17], v8 offset:0
    ds_read_b64_tr_b16 v[18:19], v8 offset:256
    s_waitcnt vmcnt(5)
    ds_read_b64_tr_b16 v[20:21], v8 offset:1024
    ds_read_b64_tr_b16 v[22:23], v8 offset:1280
    s_waitcnt vmcnt(4)
    ds_read_b64_tr_b16 v[24:25], v8 offset:2048
    ds_read_b64_tr_b16 v[26:27], v8 offset:2304
    s_waitcnt lgkmcnt(4)
    v_dot2c_f32_bf16 v12, s32, v16
    v_dot2c_f32_bf16 v13, v16, v16
    v_dot2c_f32_bf16 v12, s32, v17
    v_dot2c_f32_bf16 v13, v17, v17
    v_dot2c_f32_bf16 v12, s32, v18
    v_dot2c_f32_bf16 v13, v18, v18
    v_dot2c_f32_bf16 v12, s32, v19
    v_dot2c_f32_bf16 v13, v19, v19
    s_waitcnt vmcnt(3)
    ds_read_b64_tr_b16 v[28:29], v8 offset:3072
    ds_read_b64_tr_b16 v[30:31], v8 offset:3328
    s_waitcnt lgkmcnt(4)
    v_dot2c_f32_bf16 v12, s32, v20
    v_dot2c_f32_bf16 v13, v20, v20
    v_dot2c_f32_bf16 v12, s32, v21
    v_dot2c_f32_bf16 v13, v21, v21
    v_dot2c_f32_bf16 v12, s32, v22
    v_dot2c_f32_bf16 v13, v22, v22
    v_dot2c_f32_bf16 v12, s32, v23
    v_dot2c_f32_bf16 v13, v23, v23
    s_waitcnt vmcnt(2)
    ds_read_b64_tr_b16 v[32:33], v8 offset:4096
    ds_read_b64_tr_b16 v[34:35], v8 offset:4352
    s_waitcnt lgkmcnt(4)
    v_dot2c_f32_bf16 v12, s32, v24
    v_dot2c_f32_bf16 v13, v24, v24
    v_dot2c_f32_bf16 v12, s32, v25
    v_dot2c_f32_bf16 v13, v25, v25
    v_dot2c_f32_bf16 v12, s32, v26
    v_dot2c_f32_bf16 v13, v26, v26
    v_dot2c_f32_bf16 v12, s32, v27
    v_dot2c_f32_bf16 v13, v27, v27
    s_waitcnt vmcnt(1)
    ds_read_b64_tr_b16 v[36:37], v8 offset:5120
    ds_read_b64_tr_b16 v[38:39], v8 offset:5376
    s_waitcnt lgkmcnt(4)
    v_dot2c_f32_bf16 v12, s32, v28
    v_dot2c_f32_bf16 v13, v28, v28
    v_dot2c_f32_bf16 v12, s32, v29
    v_dot2c_f32_bf16 v13, v29, v29
    v_dot2c_f32_bf16 v12, s32, v30
    v_dot2c_f32_bf16 v13, v30, v30
    v_dot2c_f32_bf16 v12, s32, v31
    v_dot2c_f32_bf16 v13, v31, v31
    s_waitcnt vmcnt(0)
    ds_read_b64_tr_b16 v[40:41], v8 offset:6144
    ds_read_b64_tr_b16 v[42:43], v8 offset:6400
    s_waitcnt lgkmcnt(4)
    v_dot2c_f32_bf16 v12, s32, v32
    v_dot2c_f32_bf16 v13, v32, v32
    v_dot2c_f32_bf16 v12, s32, v33
    v_dot2c_f32_bf16 v13, v33, v33
    v_dot2c_f32_bf16 v12, s32, v34
    v_dot2c_f32_bf16 v13, v34, v34
    v_dot2c_f32_bf16 v12, s32, v35
    v_dot2c_f32_bf16 v13, v35, v35
    s_waitcnt lgkmcnt(2)
    v_dot2c_f32_bf16 v12, s32, v36
    v_dot2c_f32_bf16 v13, v36, v36
    v_dot2c_f32_bf16 v12, s32, v37
    v_dot2c_f32_bf16 v13, v37, v37
    v_dot2c_f32_bf16 v12, s32, v38
    v_dot2c_f32_bf16 v13, v38, v38
    v_dot2c_f32_bf16 v12, s32, v39
    v_dot2c_f32_bf16 v13, v39, v39
    s_waitcnt lgkmcnt(0)
    v_dot2c_f32_bf16 v12, s32, v40
    v_dot2c_f32_bf16 v13, v40, v40
    v_dot2c_f32_bf16 v12, s32, v41
    v_dot2c_f32_bf16 v13, v41, v41
    v_dot2c_f32_bf16 v12, s32, v42
    v_dot2c_f32_bf16 v13, v42, v42
    v_dot2c_f32_bf16 v12, s32, v43
    v_dot2c_f32_bf16 v13, v43, v43
    s_nop 2
    v_permlane32_swap_b32 v12, v13
    v_add_f32 v12, v12, v13
    ds_write_b32 v9, v12 offset:0
    s_waitcnt lgkmcnt(0)
    s_barrier
    ds_read2st64_b32 v[12:13], v10 offset0:0 offset1:1
    ds_read2st64_b32 v[14:15], v10 offset0:2 offset1:3
    s_waitcnt lgkmcnt(0)
    v_pk_add_f32 v[12:13], v[12:13], v[14:15]
    v_add_f32 v12, v12, v13
    v_mov_b32 v13, v12
    s_nop 1
    v_permlane32_swap_b32 v12, v13
    v_mul_f32 v12, 0x3b124925, v12
    v_mul_f32 v13, 0x3b124925, v13
    v_fma_f32 v13, -v12, v12, v13
    v_max_f32 v13, 0, v13
    v_cvt_pk_bf16_f32 v14, v12, v13
    v_and_b32 v13, 0xffff0000, v14
    v_add_f32 v13, 0x3727c5ac, v13
    v_cvt_pk_bf16_f32 v13, v13, v13
    v_lshlrev_b32 v13, 16, v13
    v_sqrt_f32 v13, v13
    v_lshlrev_b32 v12, 16, v14
    v_cvt_pk_bf16_f32 v13, v13, v13
    v_lshlrev_b32 v13, 16, v13
    v_cvt_pk_bf16_f32 v48, -v12, -v12
    v_cvt_pk_bf16_f32 v49, v13, v13
    buffer_store_dwordx2 v[48:49], v7, s[8:11], s33 offen sc1
    v_add_u32 v127, 393216, v127
    s_add_u32 s33, s33, 8192
    s_mov_b32 s22, 400000
k_s3_spin:
    buffer_load_dword v12, v127, s[8:11], 0 offen sc1
    s_waitcnt vmcnt(0)
    v_cmp_ne_u32 vcc, s5, v12
    s_nop 4
    s_cbranch_vccz k_s3_go
    s_sub_u32 s22, s22, 1
    s_cmp_lg_u32 s22, 0
    s_cbranch_scc1 k_s3_spin
k_s3_go:
    s_barrier
    s_add_u32 m0, s31, 8192
    s_add_u32 s30, s30, 913408
    buffer_load_dwordx4 v3, s[8:11], s30 offen offset:0 sc1 lds
    buffer_load_dwordx4 v3, s[8:11], s30 offen offset:1024 sc1 lds
    buffer_load_dwordx4 v3, s[8:11], s30 offen offset:2048 sc1 lds
    buffer_load_dwordx4 v3, s[8:11], s30 offen offset:3072 sc1 lds
    s_add_u32 m0, s31, 12288
    s_add_u32 s30, s30, 4096
    buffer_load_dwordx4 v3, s[8:11], s30 offen offset:0 sc1 lds
    buffer_load_dwordx4 v3, s[8:11], s30 offen offset:1024 sc1 lds
    buffer_load_dwordx4 v3, s[8:11], s30 offen offset:2048 sc1 lds
    v_mov_b32 v12, 0
    v_mov_b32 v13, 0
    s_waitcnt vmcnt(6)
    ds_read_b64_tr_b16 v[16:17], v8 offset:8192
    ds_read_b64_tr_b16 v[18:19], v8 offset:8448
    s_waitcnt vmcnt(5)
    ds_read_b64_tr_b16 v[20:21], v8 offset:9216
    ds_read_b64_tr_b16 v[22:23], v8 offset:9472
    s_waitcnt vmcnt(4)
    ds_read_b64_tr_b16 v[24:25], v8 offset:10240
    ds_read_b64_tr_b16 v[26:27], v8 offset:10496
    s_waitcnt lgkmcnt(4)
    v_dot2c_f32_bf16 v12, s32, v16
    v_dot2c_f32_bf16 v13, v16, v16
    v_dot2c_f32_bf16 v12, s32, v17
    v_dot2c_f32_bf16 v13, v17, v17
    v_dot2c_f32_bf16 v12, s32, v18
    v_dot2c_f32_bf16 v13, v18, v18
    v_dot2c_f32_bf16 v12, s32, v19
    v_dot2c_f32_bf16 v13, v19, v19
    s_waitcnt vmcnt(3)
    ds_read_b64_tr_b16 v[28:29], v8 offset:11264
    ds_read_b64_tr_b16 v[30:31], v8 offset:11520
    s_waitcnt lgkmcnt(4)
    v_dot2c_f32_bf16 v12, s32, v20
    v_dot2c_f32_bf16 v13, v20, v20
    v_dot2c_f32_bf16 v12, s32, v21
    v_dot2c_f32_bf16 v13, v21, v21
    v_dot2c_f32_bf16 v12, s32, v22
    v_dot2c_f32_bf16 v13, v22, v22
    v_dot2c_f32_bf16 v12, s32, v23
    v_dot2c_f32_bf16 v13, v23, v23
    s_waitcnt vmcnt(2)
    ds_read_b64_tr_b16 v[32:33], v8 offset:12288
    ds_read_b64_tr_b16 v[34:35], v8 offset:12544
    s_waitcnt lgkmcnt(4)
    v_dot2c_f32_bf16 v12, s32, v24
    v_dot2c_f32_bf16 v13, v24, v24
    v_dot2c_f32_bf16 v12, s32, v25
    v_dot2c_f32_bf16 v13, v25, v25
    v_dot2c_f32_bf16 v12, s32, v26
    v_dot2c_f32_bf16 v13, v26, v26
    v_dot2c_f32_bf16 v12, s32, v27
    v_dot2c_f32_bf16 v13, v27, v27
    s_waitcnt vmcnt(1)
    ds_read_b64_tr_b16 v[36:37], v8 offset:13312
    ds_read_b64_tr_b16 v[38:39], v8 offset:13568
    s_waitcnt lgkmcnt(4)
    v_dot2c_f32_bf16 v12, s32, v28
    v_dot2c_f32_bf16 v13, v28, v28
    v_dot2c_f32_bf16 v12, s32, v29
    v_dot2c_f32_bf16 v13, v29, v29
    v_dot2c_f32_bf16 v12, s32, v30
    v_dot2c_f32_bf16 v13, v30, v30
    v_dot2c_f32_bf16 v12, s32, v31
    v_dot2c_f32_bf16 v13, v31, v31
    s_waitcnt vmcnt(0)
    ds_read_b64_tr_b16 v[40:41], v8 offset:14336
    ds_read_b64_tr_b16 v[42:43], v8 offset:14592
    s_waitcnt lgkmcnt(4)
    v_dot2c_f32_bf16 v12, s32, v32
    v_dot2c_f32_bf16 v13, v32, v32
    v_dot2c_f32_bf16 v12, s32, v33
    v_dot2c_f32_bf16 v13, v33, v33
    v_dot2c_f32_bf16 v12, s32, v34
    v_dot2c_f32_bf16 v13, v34, v34
    v_dot2c_f32_bf16 v12, s32, v35
    v_dot2c_f32_bf16 v13, v35, v35
    s_waitcnt lgkmcnt(2)
    v_dot2c_f32_bf16 v12, s32, v36
    v_dot2c_f32_bf16 v13, v36, v36
    v_dot2c_f32_bf16 v12, s32, v37
    v_dot2c_f32_bf16 v13, v37, v37
    v_dot2c_f32_bf16 v12, s32, v38
    v_dot2c_f32_bf16 v13, v38, v38
    v_dot2c_f32_bf16 v12, s32, v39
    v_dot2c_f32_bf16 v13, v39, v39
    s_waitcnt lgkmcnt(0)
    v_dot2c_f32_bf16 v12, s32, v40
    v_dot2c_f32_bf16 v13, v40, v40
    v_dot2c_f32_bf16 v12, s32, v41
    v_dot2c_f32_bf16 v13, v41, v41
    v_dot2c_f32_bf16 v12, s32, v42
    v_dot2c_f32_bf16 v13, v42, v42
    v_dot2c_f32_bf16 v12, s32, v43
    v_dot2c_f32_bf16 v13, v43, v43
    s_nop 2
    v_permlane32_swap_b32 v12, v13
    v_add_f32 v12, v12, v13
    ds_write_b32 v9, v12 offset:1024
    s_waitcnt lgkmcnt(0)
    s_barrier
    ds_read2st64_b32 v[12:13], v10 offset0:4 offset1:5
    ds_read2st64_b32 v[14:15], v10 offset0:6 offset1:7
    s_waitcnt lgkmcnt(0)
    v_pk_add_f32 v[12:13], v[12:13], v[14:15]
    v_add_f32 v12, v12, v13
    v_mov_b32 v13, v12
    s_nop 1
    v_permlane32_swap_b32 v12, v13
    v_mul_f32 v12, 0x3b124925, v12
    v_mul_f32 v13, 0x3b124925, v13
    v_fma_f32 v13, -v12, v12, v13
    v_max_f32 v13, 0, v13
    v_cvt_pk_bf16_f32 v14, v12, v13
    v_and_b32 v13, 0xffff0000, v14
    v_add_f32 v13, 0x3727c5ac, v13
    v_cvt_pk_bf16_f32 v13, v13, v13
    v_lshlrev_b32 v13, 16, v13
    v_sqrt_f32 v13, v13
    v_lshlrev_b32 v12, 16, v14
    v_cvt_pk_bf16_f32 v13, v13, v13
    v_lshlrev_b32 v13, 16, v13
    v_cvt_pk_bf16_f32 v50, -v12, -v12
    v_cvt_pk_bf16_f32 v51, v13, v13
    buffer_store_dwordx2 v[50:51], v7, s[8:11], s33 offen sc1
    s_or_b32 s3, s2, s23
    s_cbranch_scc1 k_fin
    v_mov_b32 v12, s5
    s_mov_b32 s3, 6352896
    buffer_store_dword v12, v129, s[8:11], s3 offen sc1
    s_branch k_fin
k_tab:
    s_cmp_lg_u32 s23, 0
    s_cbranch_scc1 k_stat
    s_sub_u32 s3, s7, 28
    s_mul_i32 s3, s3, 896
    v_min_u32 v80, 55, v2
    v_lshl_add_u32 v80, v80, 4, s3
    s_mov_b32 s22, 400000
k_tab_spin:
    s_mov_b32 s3, 6957568
    buffer_load_dwordx4 v[136:139], v80, s[8:11], s3 offen sc1
    s_mov_b32 s3, 6961152
    buffer_load_dwordx4 v[140:143], v80, s[8:11], s3 offen sc1
    s_mov_b32 s3, 6964736
    buffer_load_dwordx4 v[144:147], v80, s[8:11], s3 offen sc1
    s_mov_b32 s3, 6979072
    buffer_load_dwordx4 v[148:151], v80, s[8:11], s3 offen sc1
    s_mov_b32 s3, 6982656
    buffer_load_dwordx4 v[152:155], v80, s[8:11], s3 offen sc1
    s_mov_b32 s3, 6986240
    buffer_load_dwordx4 v[156:159], v80, s[8:11], s3 offen sc1
    s_mov_b32 s3, 7000576
    buffer_load_dwordx4 v[160:163], v80, s[8:11], s3 offen sc1
    s_mov_b32 s3, 7004160
    buffer_load_dwordx4 v[164:167], v80, s[8:11], s3 offen sc1
    s_mov_b32 s3, 7007744
    buffer_load_dwordx4 v[168:171], v80, s[8:11], s3 offen sc1
    s_mov_b32 s3, 7022080
    buffer_load_dwordx4 v[172:175], v80, s[8:11], s3 offen sc1
    s_mov_b32 s3, 7025664
    buffer_load_dwordx4 v[176:179], v80, s[8:11], s3 offen sc1
    s_mov_b32 s3, 7029248
    buffer_load_dwordx4 v[180:183], v80, s[8:11], s3 offen sc1
    s_mov_b32 s3, 7043584
    buffer_load_dwordx4 v[184:187], v80, s[8:11], s3 offen sc1
    s_mov_b32 s3, 7047168
    buffer_load_dwordx4 v[188:191], v80, s[8:11], s3 offen sc1
    s_mov_b32 s3, 7050752
    buffer_load_dwordx4 v[192:195], v80, s[8:11], s3 offen sc1
    s_waitcnt vmcnt(0)
    v_xor_b32 v81, s5, v137
    v_xor_b32 v82, s5, v139
    v_xor_b32 v83, s5, v141
    v_or3_b32 v81, v81, v82, v83
    v_xor_b32 v82, s5, v143
    v_xor_b32 v83, s5, v145
    v_or3_b32 v81, v81, v82, v83
    v_xor_b32 v82, s5, v147
    v_xor_b32 v83, s5, v149
    v_or3_b32 v81, v81, v82, v83
    v_xor_b32 v82, s5, v151
    v_xor_b32 v83, s5, v153
    v_or3_b32 v81, v81, v82, v83
    v_xor_b32 v82, s5, v155
    v_xor_b32 v83, s5, v157
    v_or3_b32 v81, v81, v82, v83
    v_xor_b32 v82, s5, v159
    v_xor_b32 v83, s5, v161
    v_or3_b32 v81, v81, v82, v83
    v_xor_b32 v82, s5, v163
    v_xor_b32 v83, s5, v165
    v_or3_b32 v81, v81, v82, v83
    v_xor_b32 v82, s5, v167
    v_xor_b32 v83, s5, v169
    v_or3_b32 v81, v81, v82, v83
    v_xor_b32 v82, s5, v171
    v_xor_b32 v83, s5, v173
    v_or3_b32 v81, v81, v82, v83
    v_xor_b32 v82, s5, v175
    v_xor_b32 v83, s5, v177
    v_or3_b32 v81, v81, v82, v83
    v_xor_b32 v82, s5, v179
    v_xor_b32 v83, s5, v181
    v_or3_b32 v81, v81, v82, v83
    v_xor_b32 v82, s5, v183
    v_xor_b32 v83, s5, v185
    v_or3_b32 v81, v81, v82, v83
    v_xor_b32 v82, s5, v187
    v_xor_b32 v83, s5, v189
    v_or3_b32 v81, v81, v82, v83
    v_xor_b32 v82, s5, v191
    v_xor_b32 v83, s5, v193
    v_or3_b32 v81, v81, v82, v83
    v_xor_b32 v82, s5, v195
    v_xor_b32 v83, s5, v195
    v_or3_b32 v81, v81, v82, v83
    v_cmp_ne_u32 vcc, 0, v81
    s_nop 4
    s_cbranch_vccz k_tab_go
    s_sub_u32 s22, s22, 1
    s_cmp_lg_u32 s22, 0
    s_cbranch_scc1 k_tab_spin
k_tab_go:
    v_add_f32 v136, v136, v148
    v_add_f32 v138, v138, v150
    v_add_f32 v140, v140, v152
    v_add_f32 v142, v142, v154
    v_add_f32 v144, v144, v156
    v_add_f32 v146, v146, v158
    v_add_f32 v160, v160, v172
    v_add_f32 v162, v162, v174
    v_add_f32 v164, v164, v176
    v_add_f32 v166, v166, v178
    v_add_f32 v168, v168, v180
    v_add_f32 v170, v170, v182
    v_add_f32 v136, v136, v160
    v_add_f32 v138, v138, v162
    v_add_f32 v140, v140, v164
    v_add_f32 v142, v142, v166
    v_add_f32 v144, v144, v168
    v_add_f32 v146, v146, v170
    v_add_f32 v136, v136, v184
    v_add_f32 v138, v138, v186
    v_add_f32 v140, v140, v188
    v_add_f32 v142, v142, v190
    v_add_f32 v144, v144, v192
    v_add_f32 v146, v146, v194
    v_cvt_pk_bf16_f32 v86, v136, v138
    v_cvt_pk_bf16_f32 v85, v140, v142
    v_cvt_pk_bf16_f32 v84, v144, v146
    v_lshlrev_b32 v82, 16, v85
    v_and_b32 v83, 0xffff0000, v85
    v_add_f32 v82, 1.0, v82
    v_add_f32 v83, 1.0, v83
    v_mov_b32 v87, s5
    v_cvt_pk_bf16_f32 v85, v82, v83
    s_mov_b32 s3, 6324224
    buffer_store_dwordx4 v[84:87], v80, s[8:11], s3 offen sc1
    s_branch k_stat
k_slow_mod:
    s_mov_b32 s22, 400000
k_spin_mod:
    buffer_load_dwordx4 v[8:11], v5, s[8:11], s31 offen sc1
    s_waitcnt vmcnt(0)
    v_cmp_ne_u32 vcc, s5, v9
    v_cmp_ne_u32 s[76:77], s5, v11
    s_nop 0
    s_or_b64 vcc, vcc, s[76:77]
    s_and_b32 vcc_lo, vcc_lo, 0x001f1f1f
    s_and_b32 vcc_hi, vcc_hi, 0x1f
    s_or_b32 s3, vcc_lo, vcc_hi
    s_cbranch_scc0 k_ok_mod
    s_sub_u32 s22, s22, 1
    s_cmp_lg_u32 s22, 0
    s_cbranch_scc1 k_spin_mod
    s_branch k_ok_mod
k_slow_fe:
    s_mov_b32 s22, 400000
k_spin_fe:
    buffer_load_dword v123, v124, s[8:11], 0 offen sc1
    s_waitcnt vmcnt(0)
    v_cmp_ne_u32 vcc, s5, v123
    s_nop 1
    s_cmp_lg_u64 vcc, 0
    s_cbranch_scc0 k_ok_fe
    s_sub_u32 s22, s22, 1
    s_cmp_lg_u32 s22, 0
    s_cbranch_scc1 k_spin_fe
    s_branch k_ok_fe
k_slow_fd:
    s_mov_b32 s22, 400000
k_spin_fd:
    buffer_load_dword v125, v126, s[8:11], 0 offen sc1
    s_waitcnt vmcnt(0)
    v_cmp_ne_u32 vcc, s5, v125
    s_nop 1
    s_cmp_lg_u64 vcc, 0
    s_cbranch_scc0 k_ok_fd
    s_sub_u32 s22, s22, 1
    s_cmp_lg_u32 s22, 0
    s_cbranch_scc1 k_spin_fd
    s_branch k_ok_fd
k_slow_rk:
    s_mov_b32 s22, 400000
k_spin_rk:
    buffer_load_dwordx4 v[112:115], v7, s[8:11], s54 offen offset:0 sc1
    buffer_load_dwordx4 v[116:119], v7, s[8:11], s54 offen offset:512 sc1
    buffer_load_dwordx2 v[104:105], v5, s[8:11], s64 offen sc1
    buffer_load_dwordx2 v[106:107], v5, s[8:11], s65 offen sc1
    s_waitcnt vmcnt(0)
    v_min_u32 v130, v105, v107
    v_cmp_ne_u32 s[76:77], s5, v114
    v_cmp_ne_u32 s[78:79], s5, v118
    v_cmp_eq_u32 vcc, 0, v130
    s_or_b32 s76, s76, s78
    s_nop 0
    s_or_b32 s3, s76, vcc_lo
    s_cbranch_scc0 k_ok_rk
    s_sub_u32 s22, s22, 1
    s_cmp_lg_u32 s22, 0
    s_cbranch_scc1 k_spin_rk
    s_branch k_ok_rk
k_slow_rk2:
    s_mov_b32 s22, 400000
k_spin_rk2:
    buffer_load_dwordx2 v[108:109], v5, s[8:11], s66 offen sc1
    buffer_load_dwordx2 v[110:111], v5, s[8:11], s67 offen sc1
    s_waitcnt vmcnt(0)
    v_min_u32 v130, v109, v111
    v_cmp_eq_u32 vcc, 0, v130
    s_nop 1
    s_cmp_lg_u32 vcc_lo, 0
    s_cbranch_scc0 k_ok_rk2
    s_sub_u32 s22, s22, 1
    s_cmp_lg_u32 s22, 0
    s_cbranch_scc1 k_spin_rk2
    s_branch k_ok_rk2
k_slow_p0:
    s_mov_b32 s22, 400000
k_spin_p0:
    s_waitcnt lgkmcnt(0)
    s_cmp_ge_u32 s68, 7
    s_cbranch_scc1 k_ok_p0
    s_load_dword s68, s[8:9], s55 glc
    s_sub_u32 s22, s22, 1
    s_cmp_lg_u32 s22, 0
    s_cbranch_scc1 k_spin_p0
    s_waitcnt lgkmcnt(0)
    s_branch k_ok_p0
k_slow_p1:
    s_mov_b32 s22, 400000
k_spin_p1:
    s_waitcnt lgkmcnt(0)
    s_cmp_ge_u32 s69, 7
    s_cbranch_scc1 k_ok_p1
    s_load_dword s69, s[8:9], s56 glc
    s_sub_u32 s22, s22, 1
    s_cmp_lg_u32 s22, 0
    s_cbranch_scc1 k_spin_p1
    s_waitcnt lgkmcnt(0)
    s_branch k_ok_p1
k_slow_p2:
    s_mov_b32 s22, 400000
k_spin_p2:
    s_waitcnt lgkmcnt(0)
    s_cmp_ge_u32 s70, 7
    s_cbranch_scc1 k_ok_p2
    s_load_dword s70, s[8:9], s57 glc
    s_sub_u32 s22, s22, 1
    s_cmp_lg_u32 s22, 0
    s_cbranch_scc1 k_spin_p2
    s_waitcnt lgkmcnt(0)
    s_branch k_ok_p2
k_slow_p3:
    s_mov_b32 s22, 400000
k_spin_p3:
    s_waitcnt lgkmcnt(0)
    s_cmp_ge_u32 s71, 7
    s_cbranch_scc1 k_ok_p3
    s_load_dword s71, s[8:9], s7 glc
    s_sub_u32 s22, s22, 1
    s_cmp_lg_u32 s22, 0
    s_cbranch_scc1 k_spin_p3
    s_waitcnt lgkmcnt(0)
    s_branch k_ok_p3
k_slow_uv:
    s_mov_b32 s22, 400000
k_spin_uv:
    buffer_load_dwordx4 v[136:139], v80, s[8:11], s44 offen sc1
    s_waitcnt vmcnt(0)
    v_cmp_ne_u32 vcc, s5, v139
    s_nop 4
    s_cbranch_vccz k_uv_go
    s_sub_u32 s22, s22, 1
    s_cmp_lg_u32 s22, 0
    s_cbranch_scc1 k_spin_uv
    s_branch k_uv_go
.p2align 8
code_end:
    s_endpgm
.section .rodata,"a"
.p2align 6
.amdhsa_kernel adaLN_cond__ssm_conv_h3__glu_gated_reglu__prompt_kernel
  .amdhsa_next_free_vgpr 512
  .amdhsa_next_free_sgpr 102
  .amdhsa_accum_offset 256
  .amdhsa_group_segment_fixed_size 0
  .amdhsa_kernarg_size 120
  .amdhsa_user_sgpr_count 2
  .amdhsa_user_sgpr_kernarg_segment_ptr 1
  .amdhsa_system_sgpr_workgroup_id_x 1
  .amdhsa_float_denorm_mode_32 3
.end_amdhsa_kernel
```
